```python
import torch

def _softmax(x, axis=-1):
    return torch.softmax(x, dim=axis)
def _gelu(x):
    return torch.nn.functional.gelu(x, approximate="tanh")
def _silu(x):
    return torch.nn.functional.silu(x)
def _sigmoid(x):
    return torch.sigmoid(x)
def _layernorm(x, axis=-1, eps=1e-5):
    m = x.mean(dim=axis, keepdim=True)
    v = x.var(dim=axis, keepdim=True, unbiased=False)
    return (x - m) / torch.sqrt(v + eps)
def _scatter_add(tgt, idx, src, axis=0):
    return tgt.clone().index_add_(axis, idx, src)
def _segment_sum(src, seg, n):
    out = torch.zeros((n,) + src.shape[1:], dtype=src.dtype)
    return out.index_add_(0, seg, src)
def _pad(x, pw):
    flat = tuple(v for pair in reversed(pw) for v in pair)
    return torch.nn.functional.pad(x, flat)

kernel_name = 'concat_heads__mha_block_cached__mha_block_cached__decode'

def setup_inputs():

    _w = (lambda a: (lambda t: t.to(torch.bfloat16) if t.is_floating_point() else t)(torch.as_tensor(a)))
    def _A_setup():
        B, Sq, D = 1, 1, 512
        H, Sk, Dh = 32, 16384, 128
        return {
            "x": _w((lambda *s: torch.randn(*s, dtype=torch.bfloat16) * 0.8)(B, Sq, D)),
            "k_cache": _w((lambda *s: torch.randn(*s, dtype=torch.bfloat16) * 1.6)(B, H, Sk, Dh)),
            "v_cache": _w((lambda *s: torch.randn(*s, dtype=torch.bfloat16) * 0.2)(B, H, Sk, Dh)),
            "wq": _w((lambda *s: torch.randn(*s, dtype=torch.bfloat16) * 1.6)(D, H * Dh) * (D ** -0.5)),
            "wo": _w((lambda *s: torch.randn(*s, dtype=torch.bfloat16) * 0.2)(H * Dh, D) * ((H * Dh) ** -0.5)),
        }
    _A_in = _A_setup()

    def _B_setup():
        B, Sq, D = 1, 1, 512
        H, Sk, Dh = 32, 16384, 128
        return {
            "x": _w((lambda *s: torch.randn(*s, dtype=torch.bfloat16) * 0.8)(B, Sq, D)),
            "k_cache": _w((lambda *s: torch.randn(*s, dtype=torch.bfloat16) * 1.6)(B, H, Sk, Dh)),
            "v_cache": _w((lambda *s: torch.randn(*s, dtype=torch.bfloat16) * 0.2)(B, H, Sk, Dh)),
            "wq": _w((lambda *s: torch.randn(*s, dtype=torch.bfloat16) * 1.6)(D, H * Dh) * (D ** -0.5)),
            "wo": _w((lambda *s: torch.randn(*s, dtype=torch.bfloat16) * 0.2)(H * Dh, D) * ((H * Dh) ** -0.5)),
        }
    _B_in = _B_setup()

    return {
        "A_x": _A_in["x"],
        "A_k_cache": _A_in["k_cache"],
        "A_v_cache": _A_in["v_cache"],
        "A_wq": _A_in["wq"],
        "A_wo": _A_in["wo"],
        "B_x": _B_in["x"],
        "B_k_cache": _B_in["k_cache"],
        "B_v_cache": _B_in["v_cache"],
        "B_wq": _B_in["wq"],
        "B_wo": _B_in["wo"],
    }

def reference(A_x, A_k_cache, A_v_cache, A_wq, A_wo, B_x, B_k_cache, B_v_cache, B_wq, B_wo):
    def _A_ref(x, k_cache, v_cache, wq, wo):
        B, Sq, D = x.shape
        H, Dh = 32, 128
        q = (lambda x, *d: x.permute(*d))((x @ wq).reshape(B, Sq, H, Dh), 0, 2, 1, 3)
        scores = torch.einsum("bhqd,bhkd->bhqk", q, k_cache) * (Dh ** -0.5)
        p = _softmax(scores, axis=-1)
        o = torch.einsum("bhqk,bhkd->bhqd", p, v_cache)
        return (lambda x, *d: x.permute(*d))(o, 0, 2, 1, 3).reshape(B, Sq, H * Dh) @ wo

    def _B_ref(x, k_cache, v_cache, wq, wo):
        B, Sq, D = x.shape
        H, Dh = 32, 128
        q = (lambda x, *d: x.permute(*d))((x @ wq).reshape(B, Sq, H, Dh), 0, 2, 1, 3)
        scores = torch.einsum("bhqd,bhkd->bhqk", q, k_cache) * (Dh ** -0.5)
        p = _softmax(scores, axis=-1)
        o = torch.einsum("bhqk,bhkd->bhqd", p, v_cache)
        return (lambda x, *d: x.permute(*d))(o, 0, 2, 1, 3).reshape(B, Sq, H * Dh) @ wo

    a = _A_ref(A_x, A_k_cache, A_v_cache, A_wq, A_wo)
    b = _B_ref(B_x, B_k_cache, B_v_cache, B_wq, B_wo)
    return torch.concatenate([a, b], axis=-1)
```

```asm
; @launch grid=(256,1,1) block=(320,1,1) lds=24576
.amdgcn_target "amdgcn-amd-amdhsa--gfx950"
.text
.globl concat_heads__mha_block_cached__mha_block_cached__decode_kernel
.p2align 8
.type concat_heads__mha_block_cached__mha_block_cached__decode_kernel,@function
concat_heads__mha_block_cached__mha_block_cached__decode_kernel:
s_cmp_ge_u32 s2, 256
s_cbranch_scc1 L_end
s_load_dwordx8 s[4:11], s[0:1], 0
s_load_dwordx2 s[12:13], s[0:1], 32
s_load_dwordx8 s[16:23], s[0:1], 40
s_load_dwordx2 s[24:25], s[0:1], 72
s_load_dwordx4 s[28:31], s[0:1], 80
s_load_dwordx2 s[70:71], s[0:1], 96
s_lshr_b32 s37, s2, 3
s_and_b32 s33, s2, 7
s_lshr_b32 s36, s33, 2
s_and_b32 s34, s33, 3
s_lshl_b32 s35, s36, 5
s_or_b32 s35, s35, s37
s_lshl_b32 s79, s35, 2
s_or_b32 s79, s79, s34
v_lshrrev_b32 v20, 6, v0
v_and_b32 v32, 63, v0
v_mov_b32 v38, 0
v_readfirstlane_b32 s38, v20
s_mov_b32 s85, 0x40000
s_cmp_eq_u32 s38, 4
s_cbranch_scc1 L_ctl
v_lshlrev_b32 v1, 4, v32
s_mov_b32 s80, 0xaaaaaaaa
s_mov_b32 s81, 0xaaaaaaaa
s_mov_b32 s82, 0xcccccccc
s_mov_b32 s83, 0xcccccccc
s_mov_b32 s84, 0x3e0293ee
s_lshl_b32 s3, s38, 12
v_add_u32 v1, s3, v1
v_lshrrev_b32 v21, 4, v32
v_and_b32 v22, 7, v32
v_lshlrev_b32 v23, 3, v21
v_add_u32 v23, v23, v22
v_lshlrev_b32 v33, 1, v23
v_and_b32 v22, 3, v32
v_lshlrev_b32 v23, 2, v21
v_add_u32 v23, v23, v22
v_lshlrev_b32 v31, 2, v23
s_mul_i32 s3, s38, 2048
s_add_u32 s3, s3, 12288
v_add_u32 v31, s3, v31
v_and_b32 v22, 15, v32
v_lshlrev_b32 v22, 4, v22
v_lshlrev_b32 v39, 16, v21
v_add_u32 v39, v39, v22
v_and_b32 v23, 1, v21
v_lshlrev_b32 v23, 3, v23
v_lshrrev_b32 v25, 1, v21
v_lshlrev_b32 v25, 2, v25
v_add_u32 v23, v23, v25
v_lshlrev_b32 v22, 1, v22
v_add_u32 v35, v22, v23
s_lshl_b32 s3, s38, 9
v_add_u32 v35, s3, v35
s_lshl_b32 s77, s34, 7
s_lshl_b32 s78, s38, 5
s_add_u32 s77, s77, s78
s_mul_i32 s46, s33, 524288
v_mov_b32 v8, 0
v_mov_b32 v9, 0
v_mov_b32 v10, 0
v_mov_b32 v11, 0
v_mov_b32 v12, 0
v_mov_b32 v13, 0
v_mov_b32 v14, 0
v_mov_b32 v15, 0
s_waitcnt lgkmcnt(0)
s_cmp_eq_u32 s36, 0
s_cselect_b32 s4, s4, s16
s_cselect_b32 s5, s5, s17
s_cselect_b32 s10, s10, s22
s_cselect_b32 s11, s11, s23
s_cselect_b32 s12, s12, s24
s_cselect_b32 s13, s13, s25
s_mov_b32 s52, s4
s_mov_b32 s53, s5
s_mov_b32 s54, 1024
s_mov_b32 s55, 0x20000
s_lshl_b32 s3, s37, 8
s_sub_u32 s16, 4194304, s3
s_add_u32 s60, s10, s3
s_addc_u32 s61, s11, 0
s_mov_b32 s62, s16
s_mov_b32 s63, 0x20000
s_lshl_b32 s3, s77, 1
buffer_load_ushort v33, v33, s[52:55], s3 offen
s_lshl_b32 s3, s77, 13
buffer_load_dwordx4 v[216:219], v39, s[60:63], s3 offen nt
s_add_u32 s3, s3, 8192
buffer_load_dwordx4 v[220:223], v39, s[60:63], s3 offen nt
s_add_u32 s3, s3, 8192
buffer_load_dwordx4 v[224:227], v39, s[60:63], s3 offen nt
s_add_u32 s3, s3, 8192
buffer_load_dwordx4 v[228:231], v39, s[60:63], s3 offen nt
s_add_u32 s3, s3, 8192
buffer_load_dwordx4 v[232:235], v39, s[60:63], s3 offen nt
s_add_u32 s3, s3, 8192
buffer_load_dwordx4 v[236:239], v39, s[60:63], s3 offen nt
s_add_u32 s3, s3, 8192
buffer_load_dwordx4 v[240:243], v39, s[60:63], s3 offen nt
s_add_u32 s3, s3, 8192
buffer_load_dwordx4 v[244:247], v39, s[60:63], s3 offen nt
s_lshl_b32 s3, s37, 22
s_add_u32 s6, s6, s3
s_addc_u32 s7, s7, 0
s_add_u32 s8, s8, s3
s_addc_u32 s9, s9, 0
s_add_u32 s18, s18, s3
s_addc_u32 s19, s19, 0
s_add_u32 s20, s20, s3
s_addc_u32 s21, s21, 0
s_mov_b32 s40, s6
s_mov_b32 s41, s7
s_mov_b32 s42, 4194304
s_mov_b32 s43, 0x20000
s_lshl_b32 s3, s37, 17
s_lshl_b32 s78, s34, 8
s_add_u32 s3, s3, s78
s_sub_u32 s77, 4194304, s3
s_add_u32 s64, s12, s3
s_addc_u32 s65, s13, 0
s_mov_b32 s66, s77
s_mov_b32 s67, 0x20000
s_barrier
v_add_u32 v36, s46, v1
buffer_load_dwordx4 v[88:91], v36, s[40:43], 0 offen offset:0 nt
buffer_load_dwordx4 v[92:95], v36, s[40:43], 0 offen offset:1024 nt
buffer_load_dwordx4 v[96:99], v36, s[40:43], 0 offen offset:2048 nt
buffer_load_dwordx4 v[100:103], v36, s[40:43], 0 offen offset:3072 nt
s_add_u32 s46, s46, 16384
v_add_u32 v36, s46, v1
buffer_load_dwordx4 v[104:107], v36, s[40:43], 0 offen offset:0 nt
buffer_load_dwordx4 v[108:111], v36, s[40:43], 0 offen offset:1024 nt
buffer_load_dwordx4 v[112:115], v36, s[40:43], 0 offen offset:2048 nt
buffer_load_dwordx4 v[116:119], v36, s[40:43], 0 offen offset:3072 nt
s_add_u32 s46, s46, 16384
s_waitcnt vmcnt(8)
v_lshlrev_b32 v34, 16, v33
v_dot2c_f32_bf16_dpp v8, v33, v216 row_newbcast:0 row_mask:0xf bank_mask:0xf
s_nop 0
v_dot2c_f32_bf16_dpp v9, v34, v216 row_newbcast:0 row_mask:0xf bank_mask:0xf
v_dot2c_f32_bf16_dpp v10, v33, v217 row_newbcast:0 row_mask:0xf bank_mask:0xf
v_dot2c_f32_bf16_dpp v11, v34, v217 row_newbcast:0 row_mask:0xf bank_mask:0xf
v_dot2c_f32_bf16_dpp v12, v33, v218 row_newbcast:0 row_mask:0xf bank_mask:0xf
v_dot2c_f32_bf16_dpp v13, v34, v218 row_newbcast:0 row_mask:0xf bank_mask:0xf
v_dot2c_f32_bf16_dpp v14, v33, v219 row_newbcast:0 row_mask:0xf bank_mask:0xf
v_dot2c_f32_bf16_dpp v15, v34, v219 row_newbcast:0 row_mask:0xf bank_mask:0xf
v_dot2c_f32_bf16_dpp v8, v33, v220 row_newbcast:1 row_mask:0xf bank_mask:0xf
v_dot2c_f32_bf16_dpp v9, v34, v220 row_newbcast:1 row_mask:0xf bank_mask:0xf
v_dot2c_f32_bf16_dpp v10, v33, v221 row_newbcast:1 row_mask:0xf bank_mask:0xf
v_dot2c_f32_bf16_dpp v11, v34, v221 row_newbcast:1 row_mask:0xf bank_mask:0xf
v_dot2c_f32_bf16_dpp v12, v33, v222 row_newbcast:1 row_mask:0xf bank_mask:0xf
v_dot2c_f32_bf16_dpp v13, v34, v222 row_newbcast:1 row_mask:0xf bank_mask:0xf
v_dot2c_f32_bf16_dpp v14, v33, v223 row_newbcast:1 row_mask:0xf bank_mask:0xf
v_dot2c_f32_bf16_dpp v15, v34, v223 row_newbcast:1 row_mask:0xf bank_mask:0xf
v_dot2c_f32_bf16_dpp v8, v33, v224 row_newbcast:2 row_mask:0xf bank_mask:0xf
v_dot2c_f32_bf16_dpp v9, v34, v224 row_newbcast:2 row_mask:0xf bank_mask:0xf
v_dot2c_f32_bf16_dpp v10, v33, v225 row_newbcast:2 row_mask:0xf bank_mask:0xf
v_dot2c_f32_bf16_dpp v11, v34, v225 row_newbcast:2 row_mask:0xf bank_mask:0xf
v_dot2c_f32_bf16_dpp v12, v33, v226 row_newbcast:2 row_mask:0xf bank_mask:0xf
v_dot2c_f32_bf16_dpp v13, v34, v226 row_newbcast:2 row_mask:0xf bank_mask:0xf
v_dot2c_f32_bf16_dpp v14, v33, v227 row_newbcast:2 row_mask:0xf bank_mask:0xf
v_dot2c_f32_bf16_dpp v15, v34, v227 row_newbcast:2 row_mask:0xf bank_mask:0xf
v_dot2c_f32_bf16_dpp v8, v33, v228 row_newbcast:3 row_mask:0xf bank_mask:0xf
v_dot2c_f32_bf16_dpp v9, v34, v228 row_newbcast:3 row_mask:0xf bank_mask:0xf
v_dot2c_f32_bf16_dpp v10, v33, v229 row_newbcast:3 row_mask:0xf bank_mask:0xf
v_dot2c_f32_bf16_dpp v11, v34, v229 row_newbcast:3 row_mask:0xf bank_mask:0xf
v_dot2c_f32_bf16_dpp v12, v33, v230 row_newbcast:3 row_mask:0xf bank_mask:0xf
v_dot2c_f32_bf16_dpp v13, v34, v230 row_newbcast:3 row_mask:0xf bank_mask:0xf
v_dot2c_f32_bf16_dpp v14, v33, v231 row_newbcast:3 row_mask:0xf bank_mask:0xf
v_dot2c_f32_bf16_dpp v15, v34, v231 row_newbcast:3 row_mask:0xf bank_mask:0xf
v_dot2c_f32_bf16_dpp v8, v33, v232 row_newbcast:4 row_mask:0xf bank_mask:0xf
v_dot2c_f32_bf16_dpp v9, v34, v232 row_newbcast:4 row_mask:0xf bank_mask:0xf
v_dot2c_f32_bf16_dpp v10, v33, v233 row_newbcast:4 row_mask:0xf bank_mask:0xf
v_dot2c_f32_bf16_dpp v11, v34, v233 row_newbcast:4 row_mask:0xf bank_mask:0xf
v_dot2c_f32_bf16_dpp v12, v33, v234 row_newbcast:4 row_mask:0xf bank_mask:0xf
v_dot2c_f32_bf16_dpp v13, v34, v234 row_newbcast:4 row_mask:0xf bank_mask:0xf
v_dot2c_f32_bf16_dpp v14, v33, v235 row_newbcast:4 row_mask:0xf bank_mask:0xf
v_dot2c_f32_bf16_dpp v15, v34, v235 row_newbcast:4 row_mask:0xf bank_mask:0xf
v_dot2c_f32_bf16_dpp v8, v33, v236 row_newbcast:5 row_mask:0xf bank_mask:0xf
v_dot2c_f32_bf16_dpp v9, v34, v236 row_newbcast:5 row_mask:0xf bank_mask:0xf
v_dot2c_f32_bf16_dpp v10, v33, v237 row_newbcast:5 row_mask:0xf bank_mask:0xf
v_dot2c_f32_bf16_dpp v11, v34, v237 row_newbcast:5 row_mask:0xf bank_mask:0xf
v_dot2c_f32_bf16_dpp v12, v33, v238 row_newbcast:5 row_mask:0xf bank_mask:0xf
v_dot2c_f32_bf16_dpp v13, v34, v238 row_newbcast:5 row_mask:0xf bank_mask:0xf
v_dot2c_f32_bf16_dpp v14, v33, v239 row_newbcast:5 row_mask:0xf bank_mask:0xf
v_dot2c_f32_bf16_dpp v15, v34, v239 row_newbcast:5 row_mask:0xf bank_mask:0xf
v_dot2c_f32_bf16_dpp v8, v33, v240 row_newbcast:6 row_mask:0xf bank_mask:0xf
v_dot2c_f32_bf16_dpp v9, v34, v240 row_newbcast:6 row_mask:0xf bank_mask:0xf
v_dot2c_f32_bf16_dpp v10, v33, v241 row_newbcast:6 row_mask:0xf bank_mask:0xf
v_dot2c_f32_bf16_dpp v11, v34, v241 row_newbcast:6 row_mask:0xf bank_mask:0xf
v_dot2c_f32_bf16_dpp v12, v33, v242 row_newbcast:6 row_mask:0xf bank_mask:0xf
v_dot2c_f32_bf16_dpp v13, v34, v242 row_newbcast:6 row_mask:0xf bank_mask:0xf
v_dot2c_f32_bf16_dpp v14, v33, v243 row_newbcast:6 row_mask:0xf bank_mask:0xf
v_dot2c_f32_bf16_dpp v15, v34, v243 row_newbcast:6 row_mask:0xf bank_mask:0xf
v_dot2c_f32_bf16_dpp v8, v33, v244 row_newbcast:7 row_mask:0xf bank_mask:0xf
v_dot2c_f32_bf16_dpp v9, v34, v244 row_newbcast:7 row_mask:0xf bank_mask:0xf
v_dot2c_f32_bf16_dpp v10, v33, v245 row_newbcast:7 row_mask:0xf bank_mask:0xf
v_dot2c_f32_bf16_dpp v11, v34, v245 row_newbcast:7 row_mask:0xf bank_mask:0xf
v_dot2c_f32_bf16_dpp v12, v33, v246 row_newbcast:7 row_mask:0xf bank_mask:0xf
v_dot2c_f32_bf16_dpp v13, v34, v246 row_newbcast:7 row_mask:0xf bank_mask:0xf
v_dot2c_f32_bf16_dpp v14, v33, v247 row_newbcast:7 row_mask:0xf bank_mask:0xf
v_dot2c_f32_bf16_dpp v15, v34, v247 row_newbcast:7 row_mask:0xf bank_mask:0xf
v_permlane32_swap_b32 v8, v9
v_permlane32_swap_b32 v10, v11
v_permlane32_swap_b32 v12, v13
v_permlane32_swap_b32 v14, v15
v_add_f32 v8, v8, v9
v_add_f32 v10, v10, v11
v_add_f32 v12, v12, v13
v_add_f32 v14, v14, v15
v_permlane16_swap_b32 v8, v10
s_nop 0
v_permlane16_swap_b32 v12, v14
v_add_f32 v8, v8, v10
v_add_f32 v12, v12, v14
ds_write2_b32 v35, v8, v12 offset0:0 offset1:4
s_waitcnt lgkmcnt(0)
s_barrier
s_waitcnt vmcnt(8)
v_add_u32 v36, s46, v1
buffer_load_dwordx4 v[120:123], v36, s[40:43], 0 offen offset:0 nt
buffer_load_dwordx4 v[124:127], v36, s[40:43], 0 offen offset:1024 nt
buffer_load_dwordx4 v[128:131], v36, s[40:43], 0 offen offset:2048 nt
buffer_load_dwordx4 v[132:135], v36, s[40:43], 0 offen offset:3072 nt
s_add_u32 s46, s46, 16384
s_waitcnt vmcnt(8)
v_add_u32 v36, s46, v1
buffer_load_dwordx4 v[136:139], v36, s[40:43], 0 offen offset:0 nt
buffer_load_dwordx4 v[140:143], v36, s[40:43], 0 offen offset:1024 nt
buffer_load_dwordx4 v[144:147], v36, s[40:43], 0 offen offset:2048 nt
buffer_load_dwordx4 v[148:151], v36, s[40:43], 0 offen offset:3072 nt
s_add_u32 s46, s46, 16384
s_waitcnt vmcnt(8)
v_add_u32 v36, s46, v1
buffer_load_dwordx4 v[152:155], v36, s[40:43], 0 offen offset:0 nt
buffer_load_dwordx4 v[156:159], v36, s[40:43], 0 offen offset:1024 nt
buffer_load_dwordx4 v[160:163], v36, s[40:43], 0 offen offset:2048 nt
buffer_load_dwordx4 v[164:167], v36, s[40:43], 0 offen offset:3072 nt
s_add_u32 s46, s46, 16384
s_waitcnt vmcnt(8)
v_add_u32 v36, s46, v1
buffer_load_dwordx4 v[168:171], v36, s[40:43], 0 offen offset:0 nt
buffer_load_dwordx4 v[172:175], v36, s[40:43], 0 offen offset:1024 nt
buffer_load_dwordx4 v[176:179], v36, s[40:43], 0 offen offset:2048 nt
buffer_load_dwordx4 v[180:183], v36, s[40:43], 0 offen offset:3072 nt
s_add_u32 s46, s46, 16384
s_waitcnt vmcnt(8)
v_add_u32 v36, s46, v1
buffer_load_dwordx4 v[184:187], v36, s[40:43], 0 offen offset:0 nt
buffer_load_dwordx4 v[188:191], v36, s[40:43], 0 offen offset:1024 nt
buffer_load_dwordx4 v[192:195], v36, s[40:43], 0 offen offset:2048 nt
buffer_load_dwordx4 v[196:199], v36, s[40:43], 0 offen offset:3072 nt
s_add_u32 s46, s46, 16384
s_waitcnt vmcnt(8)
v_add_u32 v36, s46, v1
buffer_load_dwordx4 v[200:203], v36, s[40:43], 0 offen offset:0 nt
buffer_load_dwordx4 v[204:207], v36, s[40:43], 0 offen offset:1024 nt
buffer_load_dwordx4 v[208:211], v36, s[40:43], 0 offen offset:2048 nt
buffer_load_dwordx4 v[212:215], v36, s[40:43], 0 offen offset:3072 nt
s_add_u32 s46, s46, 16384
s_waitcnt vmcnt(8)
v_add_u32 v36, s46, v1
buffer_load_dwordx4 v[216:219], v36, s[40:43], 0 offen offset:0 nt
buffer_load_dwordx4 v[220:223], v36, s[40:43], 0 offen offset:1024 nt
buffer_load_dwordx4 v[224:227], v36, s[40:43], 0 offen offset:2048 nt
buffer_load_dwordx4 v[228:231], v36, s[40:43], 0 offen offset:3072 nt
s_add_u32 s46, s46, 16384
s_waitcnt vmcnt(8)
v_add_u32 v36, s46, v1
buffer_load_dwordx4 v[232:235], v36, s[40:43], 0 offen offset:0 nt
buffer_load_dwordx4 v[236:239], v36, s[40:43], 0 offen offset:1024 nt
buffer_load_dwordx4 v[240:243], v36, s[40:43], 0 offen offset:2048 nt
buffer_load_dwordx4 v[244:247], v36, s[40:43], 0 offen offset:3072 nt
s_add_u32 s46, s46, 16384
s_waitcnt vmcnt(8)
v_add_u32 v36, s46, v1
buffer_load_dwordx4 v[40:43], v36, s[40:43], 0 offen offset:0 nt
buffer_load_dwordx4 v[44:47], v36, s[40:43], 0 offen offset:1024 nt
buffer_load_dwordx4 v[48:51], v36, s[40:43], 0 offen offset:2048 nt
buffer_load_dwordx4 v[52:55], v36, s[40:43], 0 offen offset:3072 nt
s_add_u32 s46, s46, 16384
s_waitcnt vmcnt(8)
v_add_u32 v36, s46, v1
buffer_load_dwordx4 v[56:59], v36, s[40:43], 0 offen offset:0 nt
buffer_load_dwordx4 v[60:63], v36, s[40:43], 0 offen offset:1024 nt
buffer_load_dwordx4 v[64:67], v36, s[40:43], 0 offen offset:2048 nt
buffer_load_dwordx4 v[68:71], v36, s[40:43], 0 offen offset:3072 nt
s_add_u32 s46, s46, 16384
s_waitcnt vmcnt(8)
v_add_u32 v36, s46, v1
buffer_load_dwordx4 v[72:75], v36, s[40:43], 0 offen offset:0 nt
buffer_load_dwordx4 v[76:79], v36, s[40:43], 0 offen offset:1024 nt
buffer_load_dwordx4 v[80:83], v36, s[40:43], 0 offen offset:2048 nt
buffer_load_dwordx4 v[84:87], v36, s[40:43], 0 offen offset:3072 nt
s_add_u32 s46, s46, 16384
s_barrier
v_and_b32 v20, 15, v32
v_lshlrev_b32 v20, 4, v20
ds_read_b128 v[2:5], v20 offset:2048
v_mov_b32 v29, 0xff7fffff
v_mov_b32 v30, v31
s_mul_i32 s72, s33, 524288
s_add_u32 s72, s72, 163840
s_add_u32 s73, s72, 16384
s_add_u32 s74, s73, 16384
s_mov_b32 s44, 0
s_mov_b32 s45, 0
s_waitcnt lgkmcnt(0)
s_waitcnt vmcnt(48)
v_dot2_f32_bf16 v16, v88, v2, 0
v_dot2_f32_bf16 v17, v92, v2, 0
v_dot2_f32_bf16 v18, v96, v2, 0
v_dot2_f32_bf16 v19, v100, v2, 0
v_dot2_f32_bf16 v16, v89, v3, v16
v_dot2_f32_bf16 v17, v93, v3, v17
v_dot2_f32_bf16 v18, v97, v3, v18
v_dot2_f32_bf16 v19, v101, v3, v19
v_dot2_f32_bf16 v16, v90, v4, v16
v_dot2_f32_bf16 v17, v94, v4, v17
v_dot2_f32_bf16 v18, v98, v4, v18
v_dot2_f32_bf16 v19, v102, v4, v19
v_dot2_f32_bf16 v16, v91, v5, v16
v_dot2_f32_bf16 v17, v95, v5, v17
v_dot2_f32_bf16 v18, v99, v5, v18
v_dot2_f32_bf16 v19, v103, v5, v19
v_add_f32_dpp v20, v16, v16 quad_perm:[1,0,3,2] row_mask:0xf bank_mask:0xf
v_add_f32_dpp v21, v17, v17 quad_perm:[1,0,3,2] row_mask:0xf bank_mask:0xf
v_add_f32_dpp v22, v18, v18 quad_perm:[1,0,3,2] row_mask:0xf bank_mask:0xf
v_add_f32_dpp v23, v19, v19 quad_perm:[1,0,3,2] row_mask:0xf bank_mask:0xf
v_cndmask_b32 v20, v20, v21, s[80:81]
v_cndmask_b32 v22, v22, v23, s[80:81]
s_nop 0
v_add_f32_dpp v20, v20, v20 quad_perm:[2,3,0,1] row_mask:0xf bank_mask:0xf
v_add_f32_dpp v22, v22, v22 quad_perm:[2,3,0,1] row_mask:0xf bank_mask:0xf
v_cndmask_b32 v20, v20, v22, s[82:83]
s_nop 1
v_add_f32_dpp v20, v20, v20 row_ror:4 row_mask:0xf bank_mask:0xf
s_nop 1
v_add_f32_dpp v20, v20, v20 row_ror:8 row_mask:0xf bank_mask:0xf
v_mul_f32 v20, s84, v20
v_max_f32 v29, v29, v20
ds_write_b32 v30, v20
v_add_u32 v30, 64, v30
s_waitcnt vmcnt(44)
v_dot2_f32_bf16 v16, v104, v2, 0
v_dot2_f32_bf16 v17, v108, v2, 0
v_dot2_f32_bf16 v18, v112, v2, 0
v_dot2_f32_bf16 v19, v116, v2, 0
v_dot2_f32_bf16 v16, v105, v3, v16
v_dot2_f32_bf16 v17, v109, v3, v17
v_dot2_f32_bf16 v18, v113, v3, v18
v_dot2_f32_bf16 v19, v117, v3, v19
v_dot2_f32_bf16 v16, v106, v4, v16
v_dot2_f32_bf16 v17, v110, v4, v17
v_dot2_f32_bf16 v18, v114, v4, v18
v_dot2_f32_bf16 v19, v118, v4, v19
v_dot2_f32_bf16 v16, v107, v5, v16
v_dot2_f32_bf16 v17, v111, v5, v17
v_dot2_f32_bf16 v18, v115, v5, v18
v_dot2_f32_bf16 v19, v119, v5, v19
v_add_f32_dpp v20, v16, v16 quad_perm:[1,0,3,2] row_mask:0xf bank_mask:0xf
v_add_f32_dpp v21, v17, v17 quad_perm:[1,0,3,2] row_mask:0xf bank_mask:0xf
v_add_f32_dpp v22, v18, v18 quad_perm:[1,0,3,2] row_mask:0xf bank_mask:0xf
v_add_f32_dpp v23, v19, v19 quad_perm:[1,0,3,2] row_mask:0xf bank_mask:0xf
v_cndmask_b32 v20, v20, v21, s[80:81]
v_cndmask_b32 v22, v22, v23, s[80:81]
s_nop 0
v_add_f32_dpp v20, v20, v20 quad_perm:[2,3,0,1] row_mask:0xf bank_mask:0xf
v_add_f32_dpp v22, v22, v22 quad_perm:[2,3,0,1] row_mask:0xf bank_mask:0xf
v_cndmask_b32 v20, v20, v22, s[82:83]
s_nop 1
v_add_f32_dpp v20, v20, v20 row_ror:4 row_mask:0xf bank_mask:0xf
s_nop 1
v_add_f32_dpp v20, v20, v20 row_ror:8 row_mask:0xf bank_mask:0xf
v_mul_f32 v20, s84, v20
v_max_f32 v29, v29, v20
ds_write_b32 v30, v20
v_add_u32 v30, 64, v30
v_lshrrev_b32 v21, 4, v32
v_and_b32 v22, 15, v32
v_lshlrev_b32 v21, 13, v21
v_lshlrev_b32 v22, 4, v22
v_add_u32 v26, v21, v22
s_lshl_b32 s3, s38, 15
s_add_u32 s16, s3, 4096
buffer_load_dwordx4 v[88:91], v26, s[64:67], s3 offen offset:0 nt
buffer_load_dwordx4 v[92:95], v26, s[64:67], s3 offen offset:1024 nt
buffer_load_dwordx4 v[96:99], v26, s[64:67], s3 offen offset:2048 nt
buffer_load_dwordx4 v[100:103], v26, s[64:67], s3 offen offset:3072 nt
buffer_load_dwordx4 v[104:107], v26, s[64:67], s16 offen offset:0 nt
buffer_load_dwordx4 v[108:111], v26, s[64:67], s16 offen offset:1024 nt
buffer_load_dwordx4 v[112:115], v26, s[64:67], s16 offen offset:2048 nt
buffer_load_dwordx4 v[116:119], v26, s[64:67], s16 offen offset:3072 nt
s_waitcnt vmcnt(48)
v_dot2_f32_bf16 v16, v120, v2, 0
v_dot2_f32_bf16 v17, v124, v2, 0
v_dot2_f32_bf16 v18, v128, v2, 0
v_dot2_f32_bf16 v19, v132, v2, 0
v_dot2_f32_bf16 v16, v121, v3, v16
v_dot2_f32_bf16 v17, v125, v3, v17
v_dot2_f32_bf16 v18, v129, v3, v18
v_dot2_f32_bf16 v19, v133, v3, v19
v_dot2_f32_bf16 v16, v122, v4, v16
v_dot2_f32_bf16 v17, v126, v4, v17
v_dot2_f32_bf16 v18, v130, v4, v18
v_dot2_f32_bf16 v19, v134, v4, v19
v_dot2_f32_bf16 v16, v123, v5, v16
v_dot2_f32_bf16 v17, v127, v5, v17
v_dot2_f32_bf16 v18, v131, v5, v18
v_dot2_f32_bf16 v19, v135, v5, v19
v_add_f32_dpp v20, v16, v16 quad_perm:[1,0,3,2] row_mask:0xf bank_mask:0xf
v_add_f32_dpp v21, v17, v17 quad_perm:[1,0,3,2] row_mask:0xf bank_mask:0xf
v_add_f32_dpp v22, v18, v18 quad_perm:[1,0,3,2] row_mask:0xf bank_mask:0xf
v_add_f32_dpp v23, v19, v19 quad_perm:[1,0,3,2] row_mask:0xf bank_mask:0xf
v_cndmask_b32 v20, v20, v21, s[80:81]
v_cndmask_b32 v22, v22, v23, s[80:81]
s_nop 0
v_add_f32_dpp v20, v20, v20 quad_perm:[2,3,0,1] row_mask:0xf bank_mask:0xf
v_add_f32_dpp v22, v22, v22 quad_perm:[2,3,0,1] row_mask:0xf bank_mask:0xf
v_cndmask_b32 v20, v20, v22, s[82:83]
s_nop 1
v_add_f32_dpp v20, v20, v20 row_ror:4 row_mask:0xf bank_mask:0xf
s_nop 1
v_add_f32_dpp v20, v20, v20 row_ror:8 row_mask:0xf bank_mask:0xf
v_mul_f32 v20, s84, v20
v_max_f32 v29, v29, v20
ds_write_b32 v30, v20
v_add_u32 v30, 64, v30
s_waitcnt vmcnt(44)
v_dot2_f32_bf16 v16, v136, v2, 0
v_dot2_f32_bf16 v17, v140, v2, 0
v_dot2_f32_bf16 v18, v144, v2, 0
v_dot2_f32_bf16 v19, v148, v2, 0
v_dot2_f32_bf16 v16, v137, v3, v16
v_dot2_f32_bf16 v17, v141, v3, v17
v_dot2_f32_bf16 v18, v145, v3, v18
v_dot2_f32_bf16 v19, v149, v3, v19
v_dot2_f32_bf16 v16, v138, v4, v16
v_dot2_f32_bf16 v17, v142, v4, v17
v_dot2_f32_bf16 v18, v146, v4, v18
v_dot2_f32_bf16 v19, v150, v4, v19
v_dot2_f32_bf16 v16, v139, v5, v16
v_dot2_f32_bf16 v17, v143, v5, v17
v_dot2_f32_bf16 v18, v147, v5, v18
v_dot2_f32_bf16 v19, v151, v5, v19
v_add_f32_dpp v20, v16, v16 quad_perm:[1,0,3,2] row_mask:0xf bank_mask:0xf
v_add_f32_dpp v21, v17, v17 quad_perm:[1,0,3,2] row_mask:0xf bank_mask:0xf
v_add_f32_dpp v22, v18, v18 quad_perm:[1,0,3,2] row_mask:0xf bank_mask:0xf
v_add_f32_dpp v23, v19, v19 quad_perm:[1,0,3,2] row_mask:0xf bank_mask:0xf
v_cndmask_b32 v20, v20, v21, s[80:81]
v_cndmask_b32 v22, v22, v23, s[80:81]
s_nop 0
v_add_f32_dpp v20, v20, v20 quad_perm:[2,3,0,1] row_mask:0xf bank_mask:0xf
v_add_f32_dpp v22, v22, v22 quad_perm:[2,3,0,1] row_mask:0xf bank_mask:0xf
v_cndmask_b32 v20, v20, v22, s[82:83]
s_nop 1
v_add_f32_dpp v20, v20, v20 row_ror:4 row_mask:0xf bank_mask:0xf
s_nop 1
v_add_f32_dpp v20, v20, v20 row_ror:8 row_mask:0xf bank_mask:0xf
v_mul_f32 v20, s84, v20
v_max_f32 v29, v29, v20
ds_write_b32 v30, v20
v_add_u32 v30, 64, v30
s_waitcnt vmcnt(40)
v_dot2_f32_bf16 v16, v152, v2, 0
v_dot2_f32_bf16 v17, v156, v2, 0
v_dot2_f32_bf16 v18, v160, v2, 0
v_dot2_f32_bf16 v19, v164, v2, 0
v_dot2_f32_bf16 v16, v153, v3, v16
v_dot2_f32_bf16 v17, v157, v3, v17
v_dot2_f32_bf16 v18, v161, v3, v18
v_dot2_f32_bf16 v19, v165, v3, v19
v_dot2_f32_bf16 v16, v154, v4, v16
v_dot2_f32_bf16 v17, v158, v4, v17
v_dot2_f32_bf16 v18, v162, v4, v18
v_dot2_f32_bf16 v19, v166, v4, v19
v_dot2_f32_bf16 v16, v155, v5, v16
v_dot2_f32_bf16 v17, v159, v5, v17
v_dot2_f32_bf16 v18, v163, v5, v18
v_dot2_f32_bf16 v19, v167, v5, v19
v_add_f32_dpp v20, v16, v16 quad_perm:[1,0,3,2] row_mask:0xf bank_mask:0xf
v_add_f32_dpp v21, v17, v17 quad_perm:[1,0,3,2] row_mask:0xf bank_mask:0xf
v_add_f32_dpp v22, v18, v18 quad_perm:[1,0,3,2] row_mask:0xf bank_mask:0xf
v_add_f32_dpp v23, v19, v19 quad_perm:[1,0,3,2] row_mask:0xf bank_mask:0xf
v_cndmask_b32 v20, v20, v21, s[80:81]
v_cndmask_b32 v22, v22, v23, s[80:81]
s_nop 0
v_add_f32_dpp v20, v20, v20 quad_perm:[2,3,0,1] row_mask:0xf bank_mask:0xf
v_add_f32_dpp v22, v22, v22 quad_perm:[2,3,0,1] row_mask:0xf bank_mask:0xf
v_cndmask_b32 v20, v20, v22, s[82:83]
s_nop 1
v_add_f32_dpp v20, v20, v20 row_ror:4 row_mask:0xf bank_mask:0xf
s_nop 1
v_add_f32_dpp v20, v20, v20 row_ror:8 row_mask:0xf bank_mask:0xf
v_mul_f32 v20, s84, v20
v_max_f32 v29, v29, v20
ds_write_b32 v30, v20
v_add_u32 v30, 64, v30
s_waitcnt vmcnt(36)
v_dot2_f32_bf16 v16, v168, v2, 0
v_dot2_f32_bf16 v17, v172, v2, 0
v_dot2_f32_bf16 v18, v176, v2, 0
v_dot2_f32_bf16 v19, v180, v2, 0
v_dot2_f32_bf16 v16, v169, v3, v16
v_dot2_f32_bf16 v17, v173, v3, v17
v_dot2_f32_bf16 v18, v177, v3, v18
v_dot2_f32_bf16 v19, v181, v3, v19
v_dot2_f32_bf16 v16, v170, v4, v16
v_dot2_f32_bf16 v17, v174, v4, v17
v_dot2_f32_bf16 v18, v178, v4, v18
v_dot2_f32_bf16 v19, v182, v4, v19
v_dot2_f32_bf16 v16, v171, v5, v16
v_dot2_f32_bf16 v17, v175, v5, v17
v_dot2_f32_bf16 v18, v179, v5, v18
v_dot2_f32_bf16 v19, v183, v5, v19
v_add_f32_dpp v20, v16, v16 quad_perm:[1,0,3,2] row_mask:0xf bank_mask:0xf
v_add_f32_dpp v21, v17, v17 quad_perm:[1,0,3,2] row_mask:0xf bank_mask:0xf
v_add_f32_dpp v22, v18, v18 quad_perm:[1,0,3,2] row_mask:0xf bank_mask:0xf
v_add_f32_dpp v23, v19, v19 quad_perm:[1,0,3,2] row_mask:0xf bank_mask:0xf
v_cndmask_b32 v20, v20, v21, s[80:81]
v_cndmask_b32 v22, v22, v23, s[80:81]
s_nop 0
v_add_f32_dpp v20, v20, v20 quad_perm:[2,3,0,1] row_mask:0xf bank_mask:0xf
v_add_f32_dpp v22, v22, v22 quad_perm:[2,3,0,1] row_mask:0xf bank_mask:0xf
v_cndmask_b32 v20, v20, v22, s[82:83]
s_nop 1
v_add_f32_dpp v20, v20, v20 row_ror:4 row_mask:0xf bank_mask:0xf
s_nop 1
v_add_f32_dpp v20, v20, v20 row_ror:8 row_mask:0xf bank_mask:0xf
v_mul_f32 v20, s84, v20
v_max_f32 v29, v29, v20
ds_write_b32 v30, v20
v_add_u32 v30, 64, v30
s_waitcnt vmcnt(32)
v_dot2_f32_bf16 v16, v184, v2, 0
v_dot2_f32_bf16 v17, v188, v2, 0
v_dot2_f32_bf16 v18, v192, v2, 0
v_dot2_f32_bf16 v19, v196, v2, 0
v_dot2_f32_bf16 v16, v185, v3, v16
v_dot2_f32_bf16 v17, v189, v3, v17
v_dot2_f32_bf16 v18, v193, v3, v18
v_dot2_f32_bf16 v19, v197, v3, v19
v_dot2_f32_bf16 v16, v186, v4, v16
v_dot2_f32_bf16 v17, v190, v4, v17
v_dot2_f32_bf16 v18, v194, v4, v18
v_dot2_f32_bf16 v19, v198, v4, v19
v_dot2_f32_bf16 v16, v187, v5, v16
v_dot2_f32_bf16 v17, v191, v5, v17
v_dot2_f32_bf16 v18, v195, v5, v18
v_dot2_f32_bf16 v19, v199, v5, v19
v_add_f32_dpp v20, v16, v16 quad_perm:[1,0,3,2] row_mask:0xf bank_mask:0xf
v_add_f32_dpp v21, v17, v17 quad_perm:[1,0,3,2] row_mask:0xf bank_mask:0xf
v_add_f32_dpp v22, v18, v18 quad_perm:[1,0,3,2] row_mask:0xf bank_mask:0xf
v_add_f32_dpp v23, v19, v19 quad_perm:[1,0,3,2] row_mask:0xf bank_mask:0xf
v_cndmask_b32 v20, v20, v21, s[80:81]
v_cndmask_b32 v22, v22, v23, s[80:81]
s_nop 0
v_add_f32_dpp v20, v20, v20 quad_perm:[2,3,0,1] row_mask:0xf bank_mask:0xf
v_add_f32_dpp v22, v22, v22 quad_perm:[2,3,0,1] row_mask:0xf bank_mask:0xf
v_cndmask_b32 v20, v20, v22, s[82:83]
s_nop 1
v_add_f32_dpp v20, v20, v20 row_ror:4 row_mask:0xf bank_mask:0xf
s_nop 1
v_add_f32_dpp v20, v20, v20 row_ror:8 row_mask:0xf bank_mask:0xf
v_mul_f32 v20, s84, v20
v_max_f32 v29, v29, v20
ds_write_b32 v30, v20
v_add_u32 v30, 64, v30
s_waitcnt vmcnt(28)
v_dot2_f32_bf16 v16, v200, v2, 0
v_dot2_f32_bf16 v17, v204, v2, 0
v_dot2_f32_bf16 v18, v208, v2, 0
v_dot2_f32_bf16 v19, v212, v2, 0
v_dot2_f32_bf16 v16, v201, v3, v16
v_dot2_f32_bf16 v17, v205, v3, v17
v_dot2_f32_bf16 v18, v209, v3, v18
v_dot2_f32_bf16 v19, v213, v3, v19
v_dot2_f32_bf16 v16, v202, v4, v16
v_dot2_f32_bf16 v17, v206, v4, v17
v_dot2_f32_bf16 v18, v210, v4, v18
v_dot2_f32_bf16 v19, v214, v4, v19
v_dot2_f32_bf16 v16, v203, v5, v16
v_dot2_f32_bf16 v17, v207, v5, v17
v_dot2_f32_bf16 v18, v211, v5, v18
v_dot2_f32_bf16 v19, v215, v5, v19
v_add_f32_dpp v20, v16, v16 quad_perm:[1,0,3,2] row_mask:0xf bank_mask:0xf
v_add_f32_dpp v21, v17, v17 quad_perm:[1,0,3,2] row_mask:0xf bank_mask:0xf
v_add_f32_dpp v22, v18, v18 quad_perm:[1,0,3,2] row_mask:0xf bank_mask:0xf
v_add_f32_dpp v23, v19, v19 quad_perm:[1,0,3,2] row_mask:0xf bank_mask:0xf
v_cndmask_b32 v20, v20, v21, s[80:81]
v_cndmask_b32 v22, v22, v23, s[80:81]
s_nop 0
v_add_f32_dpp v20, v20, v20 quad_perm:[2,3,0,1] row_mask:0xf bank_mask:0xf
v_add_f32_dpp v22, v22, v22 quad_perm:[2,3,0,1] row_mask:0xf bank_mask:0xf
v_cndmask_b32 v20, v20, v22, s[82:83]
s_nop 1
v_add_f32_dpp v20, v20, v20 row_ror:4 row_mask:0xf bank_mask:0xf
s_nop 1
v_add_f32_dpp v20, v20, v20 row_ror:8 row_mask:0xf bank_mask:0xf
v_mul_f32 v20, s84, v20
v_max_f32 v29, v29, v20
ds_write_b32 v30, v20
v_add_u32 v30, 64, v30
s_waitcnt vmcnt(24)
v_dot2_f32_bf16 v16, v216, v2, 0
v_dot2_f32_bf16 v17, v220, v2, 0
v_dot2_f32_bf16 v18, v224, v2, 0
v_dot2_f32_bf16 v19, v228, v2, 0
v_dot2_f32_bf16 v16, v217, v3, v16
v_dot2_f32_bf16 v17, v221, v3, v17
v_dot2_f32_bf16 v18, v225, v3, v18
v_dot2_f32_bf16 v19, v229, v3, v19
v_dot2_f32_bf16 v16, v218, v4, v16
v_dot2_f32_bf16 v17, v222, v4, v17
v_dot2_f32_bf16 v18, v226, v4, v18
v_dot2_f32_bf16 v19, v230, v4, v19
v_dot2_f32_bf16 v16, v219, v5, v16
v_dot2_f32_bf16 v17, v223, v5, v17
v_dot2_f32_bf16 v18, v227, v5, v18
v_dot2_f32_bf16 v19, v231, v5, v19
v_add_f32_dpp v20, v16, v16 quad_perm:[1,0,3,2] row_mask:0xf bank_mask:0xf
v_add_f32_dpp v21, v17, v17 quad_perm:[1,0,3,2] row_mask:0xf bank_mask:0xf
v_add_f32_dpp v22, v18, v18 quad_perm:[1,0,3,2] row_mask:0xf bank_mask:0xf
v_add_f32_dpp v23, v19, v19 quad_perm:[1,0,3,2] row_mask:0xf bank_mask:0xf
v_cndmask_b32 v20, v20, v21, s[80:81]
v_cndmask_b32 v22, v22, v23, s[80:81]
s_nop 0
v_add_f32_dpp v20, v20, v20 quad_perm:[2,3,0,1] row_mask:0xf bank_mask:0xf
v_add_f32_dpp v22, v22, v22 quad_perm:[2,3,0,1] row_mask:0xf bank_mask:0xf
v_cndmask_b32 v20, v20, v22, s[82:83]
s_nop 1
v_add_f32_dpp v20, v20, v20 row_ror:4 row_mask:0xf bank_mask:0xf
s_nop 1
v_add_f32_dpp v20, v20, v20 row_ror:8 row_mask:0xf bank_mask:0xf
v_mul_f32 v20, s84, v20
v_max_f32 v29, v29, v20
ds_write_b32 v30, v20
v_add_u32 v30, 64, v30
s_waitcnt vmcnt(20)
v_dot2_f32_bf16 v16, v232, v2, 0
v_dot2_f32_bf16 v17, v236, v2, 0
v_dot2_f32_bf16 v18, v240, v2, 0
v_dot2_f32_bf16 v19, v244, v2, 0
v_dot2_f32_bf16 v16, v233, v3, v16
v_dot2_f32_bf16 v17, v237, v3, v17
v_dot2_f32_bf16 v18, v241, v3, v18
v_dot2_f32_bf16 v19, v245, v3, v19
v_dot2_f32_bf16 v16, v234, v4, v16
v_dot2_f32_bf16 v17, v238, v4, v17
v_dot2_f32_bf16 v18, v242, v4, v18
v_dot2_f32_bf16 v19, v246, v4, v19
v_dot2_f32_bf16 v16, v235, v5, v16
v_dot2_f32_bf16 v17, v239, v5, v17
v_dot2_f32_bf16 v18, v243, v5, v18
v_dot2_f32_bf16 v19, v247, v5, v19
v_add_f32_dpp v20, v16, v16 quad_perm:[1,0,3,2] row_mask:0xf bank_mask:0xf
v_add_f32_dpp v21, v17, v17 quad_perm:[1,0,3,2] row_mask:0xf bank_mask:0xf
v_add_f32_dpp v22, v18, v18 quad_perm:[1,0,3,2] row_mask:0xf bank_mask:0xf
v_add_f32_dpp v23, v19, v19 quad_perm:[1,0,3,2] row_mask:0xf bank_mask:0xf
v_cndmask_b32 v20, v20, v21, s[80:81]
v_cndmask_b32 v22, v22, v23, s[80:81]
s_nop 0
v_add_f32_dpp v20, v20, v20 quad_perm:[2,3,0,1] row_mask:0xf bank_mask:0xf
v_add_f32_dpp v22, v22, v22 quad_perm:[2,3,0,1] row_mask:0xf bank_mask:0xf
v_cndmask_b32 v20, v20, v22, s[82:83]
s_nop 1
v_add_f32_dpp v20, v20, v20 row_ror:4 row_mask:0xf bank_mask:0xf
s_nop 1
v_add_f32_dpp v20, v20, v20 row_ror:8 row_mask:0xf bank_mask:0xf
v_mul_f32 v20, s84, v20
v_max_f32 v29, v29, v20
ds_write_b32 v30, v20
v_add_u32 v30, 64, v30
L_loop:
s_cmp_ge_u32 s72, 4194304
s_cbranch_scc1 L_done
ds_read_b32 v37, v38 offset:9472
s_and_b32 s3, s72, 7
s_cmp_eq_u32 s3, s44
s_cbranch_scc1 L_notr0
s_mov_b32 s44, s3
s_cmp_ge_u32 s3, 4
s_cbranch_scc1 L_pair0
s_cmp_eq_u32 s3, 2
s_cbranch_scc1 L_trk0
v_max_f32_dpp v6, v29, v29 quad_perm:[1,0,3,2] row_mask:0xf bank_mask:0xf
s_nop 1
v_max_f32_dpp v6, v6, v6 quad_perm:[2,3,0,1] row_mask:0xf bank_mask:0xf
v_mov_b32 v7, 0
v_add_u32 v30, 0, v31
v_mov_b32 v8, 0
v_mov_b32 v9, 0
v_mov_b32 v10, 0
v_mov_b32 v11, 0
v_mov_b32 v12, 0
v_mov_b32 v13, 0
v_mov_b32 v14, 0
v_mov_b32 v15, 0
s_branch L_notr0
L_trk0:
s_nop 2
v_add_f32_dpp v7, v7, v7 quad_perm:[1,0,3,2] row_mask:0xf bank_mask:0xf
v_mov_b32 v20, v6
s_nop 0
v_add_f32_dpp v7, v7, v7 quad_perm:[2,3,0,1] row_mask:0xf bank_mask:0xf
v_mov_b32 v21, v20
s_nop 1
v_permlane32_swap_b32 v20, v21
v_max_f32 v20, v20, v21
v_mov_b32 v21, v20
s_nop 1
v_permlane16_swap_b32 v20, v21
v_max_f32 v20, v20, v21
v_sub_f32 v22, v6, v20
v_exp_f32 v22, v22
s_nop 0
v_mul_f32 v7, v7, v22
v_mul_f32 v8, v8, v22
v_mul_f32 v9, v9, v22
v_mul_f32 v10, v10, v22
v_mul_f32 v11, v11, v22
v_mul_f32 v12, v12, v22
v_mul_f32 v13, v13, v22
v_mul_f32 v14, v14, v22
v_mul_f32 v15, v15, v22
v_mov_b32 v21, v7
s_nop 1
v_permlane32_swap_b32 v7, v21
v_add_f32 v7, v7, v21
v_mov_b32 v21, v7
s_nop 1
v_permlane16_swap_b32 v7, v21
v_add_f32 v7, v7, v21
v_permlane32_swap_b32 v8, v9
v_permlane32_swap_b32 v10, v11
v_permlane32_swap_b32 v12, v13
v_permlane32_swap_b32 v14, v15
v_add_f32 v8, v8, v9
v_add_f32 v10, v10, v11
v_add_f32 v12, v12, v13
v_add_f32 v14, v14, v15
v_permlane16_swap_b32 v8, v10
s_nop 0
v_permlane16_swap_b32 v12, v14
v_add_f32 v8, v8, v10
v_add_f32 v12, v12, v14
v_add_u32 v23, 2560, v35
ds_write2_b32 v23, v8, v12 offset0:0 offset1:4
v_mov_b32 v21, v7
s_lshl_b32 s3, s38, 3
v_mov_b32 v24, s3
ds_write_b64 v24, v[20:21] offset:4608
v_and_b32 v20, 15, v32
v_lshlrev_b32 v20, 4, v20
ds_read_b128 v[2:5], v20 offset:2304
v_mov_b32 v29, 0xff7fffff
v_mov_b32 v30, v31
s_waitcnt lgkmcnt(0)
L_notr0:
s_cmp_ge_u32 s44, 4
s_cbranch_scc1 L_pair0
s_bitcmp1_b32 s44, 0
s_cbranch_scc1 L_v0
s_waitcnt vmcnt(8)
v_dot2_f32_bf16 v16, v40, v2, 0
v_dot2_f32_bf16 v17, v44, v2, 0
v_dot2_f32_bf16 v18, v48, v2, 0
v_dot2_f32_bf16 v19, v52, v2, 0
v_dot2_f32_bf16 v16, v41, v3, v16
v_dot2_f32_bf16 v17, v45, v3, v17
v_dot2_f32_bf16 v18, v49, v3, v18
v_dot2_f32_bf16 v19, v53, v3, v19
v_dot2_f32_bf16 v16, v42, v4, v16
v_dot2_f32_bf16 v17, v46, v4, v17
v_dot2_f32_bf16 v18, v50, v4, v18
v_dot2_f32_bf16 v19, v54, v4, v19
v_dot2_f32_bf16 v16, v43, v5, v16
v_dot2_f32_bf16 v17, v47, v5, v17
v_dot2_f32_bf16 v18, v51, v5, v18
v_dot2_f32_bf16 v19, v55, v5, v19
s_waitcnt lgkmcnt(0)
v_readfirstlane_b32 s76, v37
s_and_b32 s3, s76, 7
s_cmp_eq_u32 s3, s45
s_cbranch_scc1 L_samek0
s_mov_b32 s45, s3
s_cmp_eq_u32 s3, 1
s_cselect_b32 s40, s8, s20
s_cselect_b32 s41, s9, s21
s_bitcmp0_b32 s3, 0
s_cselect_b32 s40, s18, s40
s_cselect_b32 s41, s19, s41
L_samek0:
s_and_b32 s3, s76, -8
v_add_u32 v36, s3, v1
v_add_f32_dpp v20, v16, v16 quad_perm:[1,0,3,2] row_mask:0xf bank_mask:0xf
v_add_f32_dpp v21, v17, v17 quad_perm:[1,0,3,2] row_mask:0xf bank_mask:0xf
v_add_f32_dpp v22, v18, v18 quad_perm:[1,0,3,2] row_mask:0xf bank_mask:0xf
v_add_f32_dpp v23, v19, v19 quad_perm:[1,0,3,2] row_mask:0xf bank_mask:0xf
buffer_load_dwordx4 v[40:43], v36, s[40:43], 0 offen offset:0 nt
buffer_load_dwordx4 v[44:47], v36, s[40:43], 0 offen offset:1024 nt
buffer_load_dwordx4 v[48:51], v36, s[40:43], 0 offen offset:2048 nt
buffer_load_dwordx4 v[52:55], v36, s[40:43], 0 offen offset:3072 nt
v_cndmask_b32 v20, v20, v21, s[80:81]
v_cndmask_b32 v22, v22, v23, s[80:81]
s_nop 0
v_add_f32_dpp v20, v20, v20 quad_perm:[2,3,0,1] row_mask:0xf bank_mask:0xf
v_add_f32_dpp v22, v22, v22 quad_perm:[2,3,0,1] row_mask:0xf bank_mask:0xf
v_cndmask_b32 v20, v20, v22, s[82:83]
s_nop 1
v_add_f32_dpp v20, v20, v20 row_ror:4 row_mask:0xf bank_mask:0xf
s_nop 1
v_add_f32_dpp v20, v20, v20 row_ror:8 row_mask:0xf bank_mask:0xf
v_mul_f32 v20, s84, v20
v_max_f32 v29, v29, v20
ds_write_b32 v30, v20
v_add_u32 v30, 64, v30
s_branch L_tail0
L_v0:
ds_read_b32 v23, v30
s_waitcnt lgkmcnt(0)
v_sub_f32 v23, v23, v6
v_exp_f32 v23, v23
v_add_u32 v30, 64, v30
v_add_f32 v7, v7, v23
v_cvt_pk_bf16_f32 v24, v23, 0
v_cvt_pk_bf16_f32 v25, 0, v23
v_readfirstlane_b32 s76, v37
s_and_b32 s3, s76, 7
s_cmp_eq_u32 s3, s45
s_cbranch_scc1 L_samev0
s_mov_b32 s45, s3
s_cmp_eq_u32 s3, 1
s_cselect_b32 s40, s8, s20
s_cselect_b32 s41, s9, s21
s_bitcmp0_b32 s3, 0
s_cselect_b32 s40, s18, s40
s_cselect_b32 s41, s19, s41
L_samev0:
s_and_b32 s3, s76, -8
v_add_u32 v36, s3, v1
s_waitcnt vmcnt(8)
v_dot2c_f32_bf16_dpp v8, v24, v40 quad_perm:[0,0,0,0] row_mask:0xf bank_mask:0xf
v_dot2c_f32_bf16_dpp v9, v25, v40 quad_perm:[0,0,0,0] row_mask:0xf bank_mask:0xf
v_dot2c_f32_bf16_dpp v10, v24, v41 quad_perm:[0,0,0,0] row_mask:0xf bank_mask:0xf
v_dot2c_f32_bf16_dpp v11, v25, v41 quad_perm:[0,0,0,0] row_mask:0xf bank_mask:0xf
v_dot2c_f32_bf16_dpp v12, v24, v42 quad_perm:[0,0,0,0] row_mask:0xf bank_mask:0xf
v_dot2c_f32_bf16_dpp v13, v25, v42 quad_perm:[0,0,0,0] row_mask:0xf bank_mask:0xf
v_dot2c_f32_bf16_dpp v14, v24, v43 quad_perm:[0,0,0,0] row_mask:0xf bank_mask:0xf
v_dot2c_f32_bf16_dpp v15, v25, v43 quad_perm:[0,0,0,0] row_mask:0xf bank_mask:0xf
v_dot2c_f32_bf16_dpp v8, v24, v44 quad_perm:[1,1,1,1] row_mask:0xf bank_mask:0xf
v_dot2c_f32_bf16_dpp v9, v25, v44 quad_perm:[1,1,1,1] row_mask:0xf bank_mask:0xf
v_dot2c_f32_bf16_dpp v10, v24, v45 quad_perm:[1,1,1,1] row_mask:0xf bank_mask:0xf
v_dot2c_f32_bf16_dpp v11, v25, v45 quad_perm:[1,1,1,1] row_mask:0xf bank_mask:0xf
v_dot2c_f32_bf16_dpp v12, v24, v46 quad_perm:[1,1,1,1] row_mask:0xf bank_mask:0xf
v_dot2c_f32_bf16_dpp v13, v25, v46 quad_perm:[1,1,1,1] row_mask:0xf bank_mask:0xf
v_dot2c_f32_bf16_dpp v14, v24, v47 quad_perm:[1,1,1,1] row_mask:0xf bank_mask:0xf
v_dot2c_f32_bf16_dpp v15, v25, v47 quad_perm:[1,1,1,1] row_mask:0xf bank_mask:0xf
v_dot2c_f32_bf16_dpp v8, v24, v48 quad_perm:[2,2,2,2] row_mask:0xf bank_mask:0xf
v_dot2c_f32_bf16_dpp v9, v25, v48 quad_perm:[2,2,2,2] row_mask:0xf bank_mask:0xf
v_dot2c_f32_bf16_dpp v10, v24, v49 quad_perm:[2,2,2,2] row_mask:0xf bank_mask:0xf
v_dot2c_f32_bf16_dpp v11, v25, v49 quad_perm:[2,2,2,2] row_mask:0xf bank_mask:0xf
v_dot2c_f32_bf16_dpp v12, v24, v50 quad_perm:[2,2,2,2] row_mask:0xf bank_mask:0xf
v_dot2c_f32_bf16_dpp v13, v25, v50 quad_perm:[2,2,2,2] row_mask:0xf bank_mask:0xf
v_dot2c_f32_bf16_dpp v14, v24, v51 quad_perm:[2,2,2,2] row_mask:0xf bank_mask:0xf
v_dot2c_f32_bf16_dpp v15, v25, v51 quad_perm:[2,2,2,2] row_mask:0xf bank_mask:0xf
v_dot2c_f32_bf16_dpp v8, v24, v52 quad_perm:[3,3,3,3] row_mask:0xf bank_mask:0xf
v_dot2c_f32_bf16_dpp v9, v25, v52 quad_perm:[3,3,3,3] row_mask:0xf bank_mask:0xf
v_dot2c_f32_bf16_dpp v10, v24, v53 quad_perm:[3,3,3,3] row_mask:0xf bank_mask:0xf
v_dot2c_f32_bf16_dpp v11, v25, v53 quad_perm:[3,3,3,3] row_mask:0xf bank_mask:0xf
v_dot2c_f32_bf16_dpp v12, v24, v54 quad_perm:[3,3,3,3] row_mask:0xf bank_mask:0xf
v_dot2c_f32_bf16_dpp v13, v25, v54 quad_perm:[3,3,3,3] row_mask:0xf bank_mask:0xf
v_dot2c_f32_bf16_dpp v14, v24, v55 quad_perm:[3,3,3,3] row_mask:0xf bank_mask:0xf
v_dot2c_f32_bf16_dpp v15, v25, v55 quad_perm:[3,3,3,3] row_mask:0xf bank_mask:0xf
buffer_load_dwordx4 v[40:43], v36, s[40:43], 0 offen offset:0 nt
buffer_load_dwordx4 v[44:47], v36, s[40:43], 0 offen offset:1024 nt
buffer_load_dwordx4 v[48:51], v36, s[40:43], 0 offen offset:2048 nt
buffer_load_dwordx4 v[52:55], v36, s[40:43], 0 offen offset:3072 nt
s_branch L_tail0
L_pair0:
s_bitcmp1_b32 s44, 0
s_cbranch_scc1 L_pv0
s_waitcnt vmcnt(8)
v_dot2_f32_bf16 v16, v40, v2, 0
v_dot2_f32_bf16 v17, v44, v2, 0
v_dot2_f32_bf16 v18, v48, v2, 0
v_dot2_f32_bf16 v19, v52, v2, 0
v_dot2_f32_bf16 v16, v41, v3, v16
v_dot2_f32_bf16 v17, v45, v3, v17
v_dot2_f32_bf16 v18, v49, v3, v18
v_dot2_f32_bf16 v19, v53, v3, v19
v_dot2_f32_bf16 v16, v42, v4, v16
v_dot2_f32_bf16 v17, v46, v4, v17
v_dot2_f32_bf16 v18, v50, v4, v18
v_dot2_f32_bf16 v19, v54, v4, v19
v_dot2_f32_bf16 v16, v43, v5, v16
v_dot2_f32_bf16 v17, v47, v5, v17
v_dot2_f32_bf16 v18, v51, v5, v18
v_dot2_f32_bf16 v19, v55, v5, v19
s_waitcnt lgkmcnt(0)
v_readfirstlane_b32 s76, v37
s_and_b32 s3, s76, 7
s_cmp_eq_u32 s3, s45
s_cbranch_scc1 L_sameo0
s_mov_b32 s45, s3
s_cmp_eq_u32 s3, 1
s_cselect_b32 s40, s8, s20
s_cselect_b32 s41, s9, s21
s_bitcmp0_b32 s3, 0
s_cselect_b32 s40, s18, s40
s_cselect_b32 s41, s19, s41
L_sameo0:
s_and_b32 s3, s76, -8
v_add_u32 v36, s3, v1
v_add_f32_dpp v20, v16, v16 quad_perm:[1,0,3,2] row_mask:0xf bank_mask:0xf
v_add_f32_dpp v21, v17, v17 quad_perm:[1,0,3,2] row_mask:0xf bank_mask:0xf
v_add_f32_dpp v22, v18, v18 quad_perm:[1,0,3,2] row_mask:0xf bank_mask:0xf
v_add_f32_dpp v23, v19, v19 quad_perm:[1,0,3,2] row_mask:0xf bank_mask:0xf
buffer_load_dwordx4 v[40:43], v36, s[40:43], 0 offen offset:0 nt
buffer_load_dwordx4 v[44:47], v36, s[40:43], 0 offen offset:1024 nt
buffer_load_dwordx4 v[48:51], v36, s[40:43], 0 offen offset:2048 nt
buffer_load_dwordx4 v[52:55], v36, s[40:43], 0 offen offset:3072 nt
v_cndmask_b32 v20, v20, v21, s[80:81]
v_cndmask_b32 v22, v22, v23, s[80:81]
s_nop 0
v_add_f32_dpp v20, v20, v20 quad_perm:[2,3,0,1] row_mask:0xf bank_mask:0xf
v_add_f32_dpp v22, v22, v22 quad_perm:[2,3,0,1] row_mask:0xf bank_mask:0xf
v_cndmask_b32 v20, v20, v22, s[82:83]
s_nop 1
v_add_f32_dpp v20, v20, v20 row_ror:4 row_mask:0xf bank_mask:0xf
s_nop 1
v_add_f32_dpp v20, v20, v20 row_ror:8 row_mask:0xf bank_mask:0xf
v_mul_f32 v20, s84, v20
s_nop 1
v_max_f32_dpp v21, v20, v20 quad_perm:[1,0,3,2] row_mask:0xf bank_mask:0xf
s_nop 1
v_max_f32_dpp v21, v21, v21 quad_perm:[2,3,0,1] row_mask:0xf bank_mask:0xf
v_max_f32 v21, v21, v6
v_sub_f32 v22, v6, v21
v_sub_f32 v23, v20, v21
v_exp_f32 v22, v22
v_exp_f32 v23, v23
v_mov_b32 v6, v21
v_fma_f32 v7, v7, v22, v23
v_cvt_pk_bf16_f32 v24, v23, 0
v_cvt_pk_bf16_f32 v25, 0, v23
v_mul_f32 v8, v8, v22
v_mul_f32 v9, v9, v22
v_mul_f32 v10, v10, v22
v_mul_f32 v11, v11, v22
v_mul_f32 v12, v12, v22
v_mul_f32 v13, v13, v22
v_mul_f32 v14, v14, v22
v_mul_f32 v15, v15, v22
s_branch L_tail0
L_pv0:
s_waitcnt lgkmcnt(0)
v_readfirstlane_b32 s76, v37
s_and_b32 s3, s76, 7
s_cmp_eq_u32 s3, s45
s_cbranch_scc1 L_samed0
s_mov_b32 s45, s3
s_cmp_eq_u32 s3, 1
s_cselect_b32 s40, s8, s20
s_cselect_b32 s41, s9, s21
s_bitcmp0_b32 s3, 0
s_cselect_b32 s40, s18, s40
s_cselect_b32 s41, s19, s41
L_samed0:
s_and_b32 s3, s76, -8
v_add_u32 v36, s3, v1
s_waitcnt vmcnt(8)
v_dot2c_f32_bf16_dpp v8, v24, v40 quad_perm:[0,0,0,0] row_mask:0xf bank_mask:0xf
v_dot2c_f32_bf16_dpp v9, v25, v40 quad_perm:[0,0,0,0] row_mask:0xf bank_mask:0xf
v_dot2c_f32_bf16_dpp v10, v24, v41 quad_perm:[0,0,0,0] row_mask:0xf bank_mask:0xf
v_dot2c_f32_bf16_dpp v11, v25, v41 quad_perm:[0,0,0,0] row_mask:0xf bank_mask:0xf
v_dot2c_f32_bf16_dpp v12, v24, v42 quad_perm:[0,0,0,0] row_mask:0xf bank_mask:0xf
v_dot2c_f32_bf16_dpp v13, v25, v42 quad_perm:[0,0,0,0] row_mask:0xf bank_mask:0xf
v_dot2c_f32_bf16_dpp v14, v24, v43 quad_perm:[0,0,0,0] row_mask:0xf bank_mask:0xf
v_dot2c_f32_bf16_dpp v15, v25, v43 quad_perm:[0,0,0,0] row_mask:0xf bank_mask:0xf
v_dot2c_f32_bf16_dpp v8, v24, v44 quad_perm:[1,1,1,1] row_mask:0xf bank_mask:0xf
v_dot2c_f32_bf16_dpp v9, v25, v44 quad_perm:[1,1,1,1] row_mask:0xf bank_mask:0xf
v_dot2c_f32_bf16_dpp v10, v24, v45 quad_perm:[1,1,1,1] row_mask:0xf bank_mask:0xf
v_dot2c_f32_bf16_dpp v11, v25, v45 quad_perm:[1,1,1,1] row_mask:0xf bank_mask:0xf
v_dot2c_f32_bf16_dpp v12, v24, v46 quad_perm:[1,1,1,1] row_mask:0xf bank_mask:0xf
v_dot2c_f32_bf16_dpp v13, v25, v46 quad_perm:[1,1,1,1] row_mask:0xf bank_mask:0xf
v_dot2c_f32_bf16_dpp v14, v24, v47 quad_perm:[1,1,1,1] row_mask:0xf bank_mask:0xf
v_dot2c_f32_bf16_dpp v15, v25, v47 quad_perm:[1,1,1,1] row_mask:0xf bank_mask:0xf
v_dot2c_f32_bf16_dpp v8, v24, v48 quad_perm:[2,2,2,2] row_mask:0xf bank_mask:0xf
v_dot2c_f32_bf16_dpp v9, v25, v48 quad_perm:[2,2,2,2] row_mask:0xf bank_mask:0xf
v_dot2c_f32_bf16_dpp v10, v24, v49 quad_perm:[2,2,2,2] row_mask:0xf bank_mask:0xf
v_dot2c_f32_bf16_dpp v11, v25, v49 quad_perm:[2,2,2,2] row_mask:0xf bank_mask:0xf
v_dot2c_f32_bf16_dpp v12, v24, v50 quad_perm:[2,2,2,2] row_mask:0xf bank_mask:0xf
v_dot2c_f32_bf16_dpp v13, v25, v50 quad_perm:[2,2,2,2] row_mask:0xf bank_mask:0xf
v_dot2c_f32_bf16_dpp v14, v24, v51 quad_perm:[2,2,2,2] row_mask:0xf bank_mask:0xf
v_dot2c_f32_bf16_dpp v15, v25, v51 quad_perm:[2,2,2,2] row_mask:0xf bank_mask:0xf
v_dot2c_f32_bf16_dpp v8, v24, v52 quad_perm:[3,3,3,3] row_mask:0xf bank_mask:0xf
v_dot2c_f32_bf16_dpp v9, v25, v52 quad_perm:[3,3,3,3] row_mask:0xf bank_mask:0xf
v_dot2c_f32_bf16_dpp v10, v24, v53 quad_perm:[3,3,3,3] row_mask:0xf bank_mask:0xf
v_dot2c_f32_bf16_dpp v11, v25, v53 quad_perm:[3,3,3,3] row_mask:0xf bank_mask:0xf
v_dot2c_f32_bf16_dpp v12, v24, v54 quad_perm:[3,3,3,3] row_mask:0xf bank_mask:0xf
v_dot2c_f32_bf16_dpp v13, v25, v54 quad_perm:[3,3,3,3] row_mask:0xf bank_mask:0xf
v_dot2c_f32_bf16_dpp v14, v24, v55 quad_perm:[3,3,3,3] row_mask:0xf bank_mask:0xf
v_dot2c_f32_bf16_dpp v15, v25, v55 quad_perm:[3,3,3,3] row_mask:0xf bank_mask:0xf
buffer_load_dwordx4 v[40:43], v36, s[40:43], 0 offen offset:0 nt
buffer_load_dwordx4 v[44:47], v36, s[40:43], 0 offen offset:1024 nt
buffer_load_dwordx4 v[48:51], v36, s[40:43], 0 offen offset:2048 nt
buffer_load_dwordx4 v[52:55], v36, s[40:43], 0 offen offset:3072 nt
L_tail0:
s_mov_b32 s72, s76
s_barrier
s_cmp_ge_u32 s73, 4194304
s_cbranch_scc1 L_done
ds_read_b32 v37, v38 offset:9476
s_and_b32 s3, s73, 7
s_cmp_eq_u32 s3, s44
s_cbranch_scc1 L_notr1
s_mov_b32 s44, s3
s_cmp_ge_u32 s3, 4
s_cbranch_scc1 L_pair1
s_cmp_eq_u32 s3, 2
s_cbranch_scc1 L_trk1
v_max_f32_dpp v6, v29, v29 quad_perm:[1,0,3,2] row_mask:0xf bank_mask:0xf
s_nop 1
v_max_f32_dpp v6, v6, v6 quad_perm:[2,3,0,1] row_mask:0xf bank_mask:0xf
v_mov_b32 v7, 0
v_add_u32 v30, 0, v31
v_mov_b32 v8, 0
v_mov_b32 v9, 0
v_mov_b32 v10, 0
v_mov_b32 v11, 0
v_mov_b32 v12, 0
v_mov_b32 v13, 0
v_mov_b32 v14, 0
v_mov_b32 v15, 0
s_branch L_notr1
L_trk1:
s_nop 2
v_add_f32_dpp v7, v7, v7 quad_perm:[1,0,3,2] row_mask:0xf bank_mask:0xf
v_mov_b32 v20, v6
s_nop 0
v_add_f32_dpp v7, v7, v7 quad_perm:[2,3,0,1] row_mask:0xf bank_mask:0xf
v_mov_b32 v21, v20
s_nop 1
v_permlane32_swap_b32 v20, v21
v_max_f32 v20, v20, v21
v_mov_b32 v21, v20
s_nop 1
v_permlane16_swap_b32 v20, v21
v_max_f32 v20, v20, v21
v_sub_f32 v22, v6, v20
v_exp_f32 v22, v22
s_nop 0
v_mul_f32 v7, v7, v22
v_mul_f32 v8, v8, v22
v_mul_f32 v9, v9, v22
v_mul_f32 v10, v10, v22
v_mul_f32 v11, v11, v22
v_mul_f32 v12, v12, v22
v_mul_f32 v13, v13, v22
v_mul_f32 v14, v14, v22
v_mul_f32 v15, v15, v22
v_mov_b32 v21, v7
s_nop 1
v_permlane32_swap_b32 v7, v21
v_add_f32 v7, v7, v21
v_mov_b32 v21, v7
s_nop 1
v_permlane16_swap_b32 v7, v21
v_add_f32 v7, v7, v21
v_permlane32_swap_b32 v8, v9
v_permlane32_swap_b32 v10, v11
v_permlane32_swap_b32 v12, v13
v_permlane32_swap_b32 v14, v15
v_add_f32 v8, v8, v9
v_add_f32 v10, v10, v11
v_add_f32 v12, v12, v13
v_add_f32 v14, v14, v15
v_permlane16_swap_b32 v8, v10
s_nop 0
v_permlane16_swap_b32 v12, v14
v_add_f32 v8, v8, v10
v_add_f32 v12, v12, v14
v_add_u32 v23, 2560, v35
ds_write2_b32 v23, v8, v12 offset0:0 offset1:4
v_mov_b32 v21, v7
s_lshl_b32 s3, s38, 3
v_mov_b32 v24, s3
ds_write_b64 v24, v[20:21] offset:4608
v_and_b32 v20, 15, v32
v_lshlrev_b32 v20, 4, v20
ds_read_b128 v[2:5], v20 offset:2304
v_mov_b32 v29, 0xff7fffff
v_mov_b32 v30, v31
s_waitcnt lgkmcnt(0)
L_notr1:
s_cmp_ge_u32 s44, 4
s_cbranch_scc1 L_pair1
s_bitcmp1_b32 s44, 0
s_cbranch_scc1 L_v1
s_waitcnt vmcnt(8)
v_dot2_f32_bf16 v16, v56, v2, 0
v_dot2_f32_bf16 v17, v60, v2, 0
v_dot2_f32_bf16 v18, v64, v2, 0
v_dot2_f32_bf16 v19, v68, v2, 0
v_dot2_f32_bf16 v16, v57, v3, v16
v_dot2_f32_bf16 v17, v61, v3, v17
v_dot2_f32_bf16 v18, v65, v3, v18
v_dot2_f32_bf16 v19, v69, v3, v19
v_dot2_f32_bf16 v16, v58, v4, v16
v_dot2_f32_bf16 v17, v62, v4, v17
v_dot2_f32_bf16 v18, v66, v4, v18
v_dot2_f32_bf16 v19, v70, v4, v19
v_dot2_f32_bf16 v16, v59, v5, v16
v_dot2_f32_bf16 v17, v63, v5, v17
v_dot2_f32_bf16 v18, v67, v5, v18
v_dot2_f32_bf16 v19, v71, v5, v19
s_waitcnt lgkmcnt(0)
v_readfirstlane_b32 s76, v37
s_and_b32 s3, s76, 7
s_cmp_eq_u32 s3, s45
s_cbranch_scc1 L_samek1
s_mov_b32 s45, s3
s_cmp_eq_u32 s3, 1
s_cselect_b32 s40, s8, s20
s_cselect_b32 s41, s9, s21
s_bitcmp0_b32 s3, 0
s_cselect_b32 s40, s18, s40
s_cselect_b32 s41, s19, s41
L_samek1:
s_and_b32 s3, s76, -8
v_add_u32 v36, s3, v1
v_add_f32_dpp v20, v16, v16 quad_perm:[1,0,3,2] row_mask:0xf bank_mask:0xf
v_add_f32_dpp v21, v17, v17 quad_perm:[1,0,3,2] row_mask:0xf bank_mask:0xf
v_add_f32_dpp v22, v18, v18 quad_perm:[1,0,3,2] row_mask:0xf bank_mask:0xf
v_add_f32_dpp v23, v19, v19 quad_perm:[1,0,3,2] row_mask:0xf bank_mask:0xf
buffer_load_dwordx4 v[56:59], v36, s[40:43], 0 offen offset:0 nt
buffer_load_dwordx4 v[60:63], v36, s[40:43], 0 offen offset:1024 nt
buffer_load_dwordx4 v[64:67], v36, s[40:43], 0 offen offset:2048 nt
buffer_load_dwordx4 v[68:71], v36, s[40:43], 0 offen offset:3072 nt
v_cndmask_b32 v20, v20, v21, s[80:81]
v_cndmask_b32 v22, v22, v23, s[80:81]
s_nop 0
v_add_f32_dpp v20, v20, v20 quad_perm:[2,3,0,1] row_mask:0xf bank_mask:0xf
v_add_f32_dpp v22, v22, v22 quad_perm:[2,3,0,1] row_mask:0xf bank_mask:0xf
v_cndmask_b32 v20, v20, v22, s[82:83]
s_nop 1
v_add_f32_dpp v20, v20, v20 row_ror:4 row_mask:0xf bank_mask:0xf
s_nop 1
v_add_f32_dpp v20, v20, v20 row_ror:8 row_mask:0xf bank_mask:0xf
v_mul_f32 v20, s84, v20
v_max_f32 v29, v29, v20
ds_write_b32 v30, v20
v_add_u32 v30, 64, v30
s_branch L_tail1
L_v1:
ds_read_b32 v23, v30
s_waitcnt lgkmcnt(0)
v_sub_f32 v23, v23, v6
v_exp_f32 v23, v23
v_add_u32 v30, 64, v30
v_add_f32 v7, v7, v23
v_cvt_pk_bf16_f32 v24, v23, 0
v_cvt_pk_bf16_f32 v25, 0, v23
v_readfirstlane_b32 s76, v37
s_and_b32 s3, s76, 7
s_cmp_eq_u32 s3, s45
s_cbranch_scc1 L_samev1
s_mov_b32 s45, s3
s_cmp_eq_u32 s3, 1
s_cselect_b32 s40, s8, s20
s_cselect_b32 s41, s9, s21
s_bitcmp0_b32 s3, 0
s_cselect_b32 s40, s18, s40
s_cselect_b32 s41, s19, s41
L_samev1:
s_and_b32 s3, s76, -8
v_add_u32 v36, s3, v1
s_waitcnt vmcnt(8)
v_dot2c_f32_bf16_dpp v8, v24, v56 quad_perm:[0,0,0,0] row_mask:0xf bank_mask:0xf
v_dot2c_f32_bf16_dpp v9, v25, v56 quad_perm:[0,0,0,0] row_mask:0xf bank_mask:0xf
v_dot2c_f32_bf16_dpp v10, v24, v57 quad_perm:[0,0,0,0] row_mask:0xf bank_mask:0xf
v_dot2c_f32_bf16_dpp v11, v25, v57 quad_perm:[0,0,0,0] row_mask:0xf bank_mask:0xf
v_dot2c_f32_bf16_dpp v12, v24, v58 quad_perm:[0,0,0,0] row_mask:0xf bank_mask:0xf
v_dot2c_f32_bf16_dpp v13, v25, v58 quad_perm:[0,0,0,0] row_mask:0xf bank_mask:0xf
v_dot2c_f32_bf16_dpp v14, v24, v59 quad_perm:[0,0,0,0] row_mask:0xf bank_mask:0xf
v_dot2c_f32_bf16_dpp v15, v25, v59 quad_perm:[0,0,0,0] row_mask:0xf bank_mask:0xf
v_dot2c_f32_bf16_dpp v8, v24, v60 quad_perm:[1,1,1,1] row_mask:0xf bank_mask:0xf
v_dot2c_f32_bf16_dpp v9, v25, v60 quad_perm:[1,1,1,1] row_mask:0xf bank_mask:0xf
v_dot2c_f32_bf16_dpp v10, v24, v61 quad_perm:[1,1,1,1] row_mask:0xf bank_mask:0xf
v_dot2c_f32_bf16_dpp v11, v25, v61 quad_perm:[1,1,1,1] row_mask:0xf bank_mask:0xf
v_dot2c_f32_bf16_dpp v12, v24, v62 quad_perm:[1,1,1,1] row_mask:0xf bank_mask:0xf
v_dot2c_f32_bf16_dpp v13, v25, v62 quad_perm:[1,1,1,1] row_mask:0xf bank_mask:0xf
v_dot2c_f32_bf16_dpp v14, v24, v63 quad_perm:[1,1,1,1] row_mask:0xf bank_mask:0xf
v_dot2c_f32_bf16_dpp v15, v25, v63 quad_perm:[1,1,1,1] row_mask:0xf bank_mask:0xf
v_dot2c_f32_bf16_dpp v8, v24, v64 quad_perm:[2,2,2,2] row_mask:0xf bank_mask:0xf
v_dot2c_f32_bf16_dpp v9, v25, v64 quad_perm:[2,2,2,2] row_mask:0xf bank_mask:0xf
v_dot2c_f32_bf16_dpp v10, v24, v65 quad_perm:[2,2,2,2] row_mask:0xf bank_mask:0xf
v_dot2c_f32_bf16_dpp v11, v25, v65 quad_perm:[2,2,2,2] row_mask:0xf bank_mask:0xf
v_dot2c_f32_bf16_dpp v12, v24, v66 quad_perm:[2,2,2,2] row_mask:0xf bank_mask:0xf
v_dot2c_f32_bf16_dpp v13, v25, v66 quad_perm:[2,2,2,2] row_mask:0xf bank_mask:0xf
v_dot2c_f32_bf16_dpp v14, v24, v67 quad_perm:[2,2,2,2] row_mask:0xf bank_mask:0xf
v_dot2c_f32_bf16_dpp v15, v25, v67 quad_perm:[2,2,2,2] row_mask:0xf bank_mask:0xf
v_dot2c_f32_bf16_dpp v8, v24, v68 quad_perm:[3,3,3,3] row_mask:0xf bank_mask:0xf
v_dot2c_f32_bf16_dpp v9, v25, v68 quad_perm:[3,3,3,3] row_mask:0xf bank_mask:0xf
v_dot2c_f32_bf16_dpp v10, v24, v69 quad_perm:[3,3,3,3] row_mask:0xf bank_mask:0xf
v_dot2c_f32_bf16_dpp v11, v25, v69 quad_perm:[3,3,3,3] row_mask:0xf bank_mask:0xf
v_dot2c_f32_bf16_dpp v12, v24, v70 quad_perm:[3,3,3,3] row_mask:0xf bank_mask:0xf
v_dot2c_f32_bf16_dpp v13, v25, v70 quad_perm:[3,3,3,3] row_mask:0xf bank_mask:0xf
v_dot2c_f32_bf16_dpp v14, v24, v71 quad_perm:[3,3,3,3] row_mask:0xf bank_mask:0xf
v_dot2c_f32_bf16_dpp v15, v25, v71 quad_perm:[3,3,3,3] row_mask:0xf bank_mask:0xf
buffer_load_dwordx4 v[56:59], v36, s[40:43], 0 offen offset:0 nt
buffer_load_dwordx4 v[60:63], v36, s[40:43], 0 offen offset:1024 nt
buffer_load_dwordx4 v[64:67], v36, s[40:43], 0 offen offset:2048 nt
buffer_load_dwordx4 v[68:71], v36, s[40:43], 0 offen offset:3072 nt
s_branch L_tail1
L_pair1:
s_bitcmp1_b32 s44, 0
s_cbranch_scc1 L_pv1
s_waitcnt vmcnt(8)
v_dot2_f32_bf16 v16, v56, v2, 0
v_dot2_f32_bf16 v17, v60, v2, 0
v_dot2_f32_bf16 v18, v64, v2, 0
v_dot2_f32_bf16 v19, v68, v2, 0
v_dot2_f32_bf16 v16, v57, v3, v16
v_dot2_f32_bf16 v17, v61, v3, v17
v_dot2_f32_bf16 v18, v65, v3, v18
v_dot2_f32_bf16 v19, v69, v3, v19
v_dot2_f32_bf16 v16, v58, v4, v16
v_dot2_f32_bf16 v17, v62, v4, v17
v_dot2_f32_bf16 v18, v66, v4, v18
v_dot2_f32_bf16 v19, v70, v4, v19
v_dot2_f32_bf16 v16, v59, v5, v16
v_dot2_f32_bf16 v17, v63, v5, v17
v_dot2_f32_bf16 v18, v67, v5, v18
v_dot2_f32_bf16 v19, v71, v5, v19
s_waitcnt lgkmcnt(0)
v_readfirstlane_b32 s76, v37
s_and_b32 s3, s76, 7
s_cmp_eq_u32 s3, s45
s_cbranch_scc1 L_sameo1
s_mov_b32 s45, s3
s_cmp_eq_u32 s3, 1
s_cselect_b32 s40, s8, s20
s_cselect_b32 s41, s9, s21
s_bitcmp0_b32 s3, 0
s_cselect_b32 s40, s18, s40
s_cselect_b32 s41, s19, s41
L_sameo1:
s_and_b32 s3, s76, -8
v_add_u32 v36, s3, v1
v_add_f32_dpp v20, v16, v16 quad_perm:[1,0,3,2] row_mask:0xf bank_mask:0xf
v_add_f32_dpp v21, v17, v17 quad_perm:[1,0,3,2] row_mask:0xf bank_mask:0xf
v_add_f32_dpp v22, v18, v18 quad_perm:[1,0,3,2] row_mask:0xf bank_mask:0xf
v_add_f32_dpp v23, v19, v19 quad_perm:[1,0,3,2] row_mask:0xf bank_mask:0xf
buffer_load_dwordx4 v[56:59], v36, s[40:43], 0 offen offset:0 nt
buffer_load_dwordx4 v[60:63], v36, s[40:43], 0 offen offset:1024 nt
buffer_load_dwordx4 v[64:67], v36, s[40:43], 0 offen offset:2048 nt
buffer_load_dwordx4 v[68:71], v36, s[40:43], 0 offen offset:3072 nt
v_cndmask_b32 v20, v20, v21, s[80:81]
v_cndmask_b32 v22, v22, v23, s[80:81]
s_nop 0
v_add_f32_dpp v20, v20, v20 quad_perm:[2,3,0,1] row_mask:0xf bank_mask:0xf
v_add_f32_dpp v22, v22, v22 quad_perm:[2,3,0,1] row_mask:0xf bank_mask:0xf
v_cndmask_b32 v20, v20, v22, s[82:83]
s_nop 1
v_add_f32_dpp v20, v20, v20 row_ror:4 row_mask:0xf bank_mask:0xf
s_nop 1
v_add_f32_dpp v20, v20, v20 row_ror:8 row_mask:0xf bank_mask:0xf
v_mul_f32 v20, s84, v20
s_nop 1
v_max_f32_dpp v21, v20, v20 quad_perm:[1,0,3,2] row_mask:0xf bank_mask:0xf
s_nop 1
v_max_f32_dpp v21, v21, v21 quad_perm:[2,3,0,1] row_mask:0xf bank_mask:0xf
v_max_f32 v21, v21, v6
v_sub_f32 v22, v6, v21
v_sub_f32 v23, v20, v21
v_exp_f32 v22, v22
v_exp_f32 v23, v23
v_mov_b32 v6, v21
v_fma_f32 v7, v7, v22, v23
v_cvt_pk_bf16_f32 v24, v23, 0
v_cvt_pk_bf16_f32 v25, 0, v23
v_mul_f32 v8, v8, v22
v_mul_f32 v9, v9, v22
v_mul_f32 v10, v10, v22
v_mul_f32 v11, v11, v22
v_mul_f32 v12, v12, v22
v_mul_f32 v13, v13, v22
v_mul_f32 v14, v14, v22
v_mul_f32 v15, v15, v22
s_branch L_tail1
L_pv1:
s_waitcnt lgkmcnt(0)
v_readfirstlane_b32 s76, v37
s_and_b32 s3, s76, 7
s_cmp_eq_u32 s3, s45
s_cbranch_scc1 L_samed1
s_mov_b32 s45, s3
s_cmp_eq_u32 s3, 1
s_cselect_b32 s40, s8, s20
s_cselect_b32 s41, s9, s21
s_bitcmp0_b32 s3, 0
s_cselect_b32 s40, s18, s40
s_cselect_b32 s41, s19, s41
L_samed1:
s_and_b32 s3, s76, -8
v_add_u32 v36, s3, v1
s_waitcnt vmcnt(8)
v_dot2c_f32_bf16_dpp v8, v24, v56 quad_perm:[0,0,0,0] row_mask:0xf bank_mask:0xf
v_dot2c_f32_bf16_dpp v9, v25, v56 quad_perm:[0,0,0,0] row_mask:0xf bank_mask:0xf
v_dot2c_f32_bf16_dpp v10, v24, v57 quad_perm:[0,0,0,0] row_mask:0xf bank_mask:0xf
v_dot2c_f32_bf16_dpp v11, v25, v57 quad_perm:[0,0,0,0] row_mask:0xf bank_mask:0xf
v_dot2c_f32_bf16_dpp v12, v24, v58 quad_perm:[0,0,0,0] row_mask:0xf bank_mask:0xf
v_dot2c_f32_bf16_dpp v13, v25, v58 quad_perm:[0,0,0,0] row_mask:0xf bank_mask:0xf
v_dot2c_f32_bf16_dpp v14, v24, v59 quad_perm:[0,0,0,0] row_mask:0xf bank_mask:0xf
v_dot2c_f32_bf16_dpp v15, v25, v59 quad_perm:[0,0,0,0] row_mask:0xf bank_mask:0xf
v_dot2c_f32_bf16_dpp v8, v24, v60 quad_perm:[1,1,1,1] row_mask:0xf bank_mask:0xf
v_dot2c_f32_bf16_dpp v9, v25, v60 quad_perm:[1,1,1,1] row_mask:0xf bank_mask:0xf
v_dot2c_f32_bf16_dpp v10, v24, v61 quad_perm:[1,1,1,1] row_mask:0xf bank_mask:0xf
v_dot2c_f32_bf16_dpp v11, v25, v61 quad_perm:[1,1,1,1] row_mask:0xf bank_mask:0xf
v_dot2c_f32_bf16_dpp v12, v24, v62 quad_perm:[1,1,1,1] row_mask:0xf bank_mask:0xf
v_dot2c_f32_bf16_dpp v13, v25, v62 quad_perm:[1,1,1,1] row_mask:0xf bank_mask:0xf
v_dot2c_f32_bf16_dpp v14, v24, v63 quad_perm:[1,1,1,1] row_mask:0xf bank_mask:0xf
v_dot2c_f32_bf16_dpp v15, v25, v63 quad_perm:[1,1,1,1] row_mask:0xf bank_mask:0xf
v_dot2c_f32_bf16_dpp v8, v24, v64 quad_perm:[2,2,2,2] row_mask:0xf bank_mask:0xf
v_dot2c_f32_bf16_dpp v9, v25, v64 quad_perm:[2,2,2,2] row_mask:0xf bank_mask:0xf
v_dot2c_f32_bf16_dpp v10, v24, v65 quad_perm:[2,2,2,2] row_mask:0xf bank_mask:0xf
v_dot2c_f32_bf16_dpp v11, v25, v65 quad_perm:[2,2,2,2] row_mask:0xf bank_mask:0xf
v_dot2c_f32_bf16_dpp v12, v24, v66 quad_perm:[2,2,2,2] row_mask:0xf bank_mask:0xf
v_dot2c_f32_bf16_dpp v13, v25, v66 quad_perm:[2,2,2,2] row_mask:0xf bank_mask:0xf
v_dot2c_f32_bf16_dpp v14, v24, v67 quad_perm:[2,2,2,2] row_mask:0xf bank_mask:0xf
v_dot2c_f32_bf16_dpp v15, v25, v67 quad_perm:[2,2,2,2] row_mask:0xf bank_mask:0xf
v_dot2c_f32_bf16_dpp v8, v24, v68 quad_perm:[3,3,3,3] row_mask:0xf bank_mask:0xf
v_dot2c_f32_bf16_dpp v9, v25, v68 quad_perm:[3,3,3,3] row_mask:0xf bank_mask:0xf
v_dot2c_f32_bf16_dpp v10, v24, v69 quad_perm:[3,3,3,3] row_mask:0xf bank_mask:0xf
v_dot2c_f32_bf16_dpp v11, v25, v69 quad_perm:[3,3,3,3] row_mask:0xf bank_mask:0xf
v_dot2c_f32_bf16_dpp v12, v24, v70 quad_perm:[3,3,3,3] row_mask:0xf bank_mask:0xf
v_dot2c_f32_bf16_dpp v13, v25, v70 quad_perm:[3,3,3,3] row_mask:0xf bank_mask:0xf
v_dot2c_f32_bf16_dpp v14, v24, v71 quad_perm:[3,3,3,3] row_mask:0xf bank_mask:0xf
v_dot2c_f32_bf16_dpp v15, v25, v71 quad_perm:[3,3,3,3] row_mask:0xf bank_mask:0xf
buffer_load_dwordx4 v[56:59], v36, s[40:43], 0 offen offset:0 nt
buffer_load_dwordx4 v[60:63], v36, s[40:43], 0 offen offset:1024 nt
buffer_load_dwordx4 v[64:67], v36, s[40:43], 0 offen offset:2048 nt
buffer_load_dwordx4 v[68:71], v36, s[40:43], 0 offen offset:3072 nt
L_tail1:
s_mov_b32 s73, s76
s_barrier
s_cmp_ge_u32 s74, 4194304
s_cbranch_scc1 L_done
ds_read_b32 v37, v38 offset:9480
s_and_b32 s3, s74, 7
s_cmp_eq_u32 s3, s44
s_cbranch_scc1 L_notr2
s_mov_b32 s44, s3
s_cmp_ge_u32 s3, 4
s_cbranch_scc1 L_pair2
s_cmp_eq_u32 s3, 2
s_cbranch_scc1 L_trk2
v_max_f32_dpp v6, v29, v29 quad_perm:[1,0,3,2] row_mask:0xf bank_mask:0xf
s_nop 1
v_max_f32_dpp v6, v6, v6 quad_perm:[2,3,0,1] row_mask:0xf bank_mask:0xf
v_mov_b32 v7, 0
v_add_u32 v30, 0, v31
v_mov_b32 v8, 0
v_mov_b32 v9, 0
v_mov_b32 v10, 0
v_mov_b32 v11, 0
v_mov_b32 v12, 0
v_mov_b32 v13, 0
v_mov_b32 v14, 0
v_mov_b32 v15, 0
s_branch L_notr2
L_trk2:
s_nop 2
v_add_f32_dpp v7, v7, v7 quad_perm:[1,0,3,2] row_mask:0xf bank_mask:0xf
v_mov_b32 v20, v6
s_nop 0
v_add_f32_dpp v7, v7, v7 quad_perm:[2,3,0,1] row_mask:0xf bank_mask:0xf
v_mov_b32 v21, v20
s_nop 1
v_permlane32_swap_b32 v20, v21
v_max_f32 v20, v20, v21
v_mov_b32 v21, v20
s_nop 1
v_permlane16_swap_b32 v20, v21
v_max_f32 v20, v20, v21
v_sub_f32 v22, v6, v20
v_exp_f32 v22, v22
s_nop 0
v_mul_f32 v7, v7, v22
v_mul_f32 v8, v8, v22
v_mul_f32 v9, v9, v22
v_mul_f32 v10, v10, v22
v_mul_f32 v11, v11, v22
v_mul_f32 v12, v12, v22
v_mul_f32 v13, v13, v22
v_mul_f32 v14, v14, v22
v_mul_f32 v15, v15, v22
v_mov_b32 v21, v7
s_nop 1
v_permlane32_swap_b32 v7, v21
v_add_f32 v7, v7, v21
v_mov_b32 v21, v7
s_nop 1
v_permlane16_swap_b32 v7, v21
v_add_f32 v7, v7, v21
v_permlane32_swap_b32 v8, v9
v_permlane32_swap_b32 v10, v11
v_permlane32_swap_b32 v12, v13
v_permlane32_swap_b32 v14, v15
v_add_f32 v8, v8, v9
v_add_f32 v10, v10, v11
v_add_f32 v12, v12, v13
v_add_f32 v14, v14, v15
v_permlane16_swap_b32 v8, v10
s_nop 0
v_permlane16_swap_b32 v12, v14
v_add_f32 v8, v8, v10
v_add_f32 v12, v12, v14
v_add_u32 v23, 2560, v35
ds_write2_b32 v23, v8, v12 offset0:0 offset1:4
v_mov_b32 v21, v7
s_lshl_b32 s3, s38, 3
v_mov_b32 v24, s3
ds_write_b64 v24, v[20:21] offset:4608
v_and_b32 v20, 15, v32
v_lshlrev_b32 v20, 4, v20
ds_read_b128 v[2:5], v20 offset:2304
v_mov_b32 v29, 0xff7fffff
v_mov_b32 v30, v31
s_waitcnt lgkmcnt(0)
L_notr2:
s_cmp_ge_u32 s44, 4
s_cbranch_scc1 L_pair2
s_bitcmp1_b32 s44, 0
s_cbranch_scc1 L_v2
s_waitcnt vmcnt(8)
v_dot2_f32_bf16 v16, v72, v2, 0
v_dot2_f32_bf16 v17, v76, v2, 0
v_dot2_f32_bf16 v18, v80, v2, 0
v_dot2_f32_bf16 v19, v84, v2, 0
v_dot2_f32_bf16 v16, v73, v3, v16
v_dot2_f32_bf16 v17, v77, v3, v17
v_dot2_f32_bf16 v18, v81, v3, v18
v_dot2_f32_bf16 v19, v85, v3, v19
v_dot2_f32_bf16 v16, v74, v4, v16
v_dot2_f32_bf16 v17, v78, v4, v17
v_dot2_f32_bf16 v18, v82, v4, v18
v_dot2_f32_bf16 v19, v86, v4, v19
v_dot2_f32_bf16 v16, v75, v5, v16
v_dot2_f32_bf16 v17, v79, v5, v17
v_dot2_f32_bf16 v18, v83, v5, v18
v_dot2_f32_bf16 v19, v87, v5, v19
s_waitcnt lgkmcnt(0)
v_readfirstlane_b32 s76, v37
s_and_b32 s3, s76, 7
s_cmp_eq_u32 s3, s45
s_cbranch_scc1 L_samek2
s_mov_b32 s45, s3
s_cmp_eq_u32 s3, 1
s_cselect_b32 s40, s8, s20
s_cselect_b32 s41, s9, s21
s_bitcmp0_b32 s3, 0
s_cselect_b32 s40, s18, s40
s_cselect_b32 s41, s19, s41
L_samek2:
s_and_b32 s3, s76, -8
v_add_u32 v36, s3, v1
v_add_f32_dpp v20, v16, v16 quad_perm:[1,0,3,2] row_mask:0xf bank_mask:0xf
v_add_f32_dpp v21, v17, v17 quad_perm:[1,0,3,2] row_mask:0xf bank_mask:0xf
v_add_f32_dpp v22, v18, v18 quad_perm:[1,0,3,2] row_mask:0xf bank_mask:0xf
v_add_f32_dpp v23, v19, v19 quad_perm:[1,0,3,2] row_mask:0xf bank_mask:0xf
buffer_load_dwordx4 v[72:75], v36, s[40:43], 0 offen offset:0 nt
buffer_load_dwordx4 v[76:79], v36, s[40:43], 0 offen offset:1024 nt
buffer_load_dwordx4 v[80:83], v36, s[40:43], 0 offen offset:2048 nt
buffer_load_dwordx4 v[84:87], v36, s[40:43], 0 offen offset:3072 nt
v_cndmask_b32 v20, v20, v21, s[80:81]
v_cndmask_b32 v22, v22, v23, s[80:81]
s_nop 0
v_add_f32_dpp v20, v20, v20 quad_perm:[2,3,0,1] row_mask:0xf bank_mask:0xf
v_add_f32_dpp v22, v22, v22 quad_perm:[2,3,0,1] row_mask:0xf bank_mask:0xf
v_cndmask_b32 v20, v20, v22, s[82:83]
s_nop 1
v_add_f32_dpp v20, v20, v20 row_ror:4 row_mask:0xf bank_mask:0xf
s_nop 1
v_add_f32_dpp v20, v20, v20 row_ror:8 row_mask:0xf bank_mask:0xf
v_mul_f32 v20, s84, v20
v_max_f32 v29, v29, v20
ds_write_b32 v30, v20
v_add_u32 v30, 64, v30
s_branch L_tail2
L_v2:
ds_read_b32 v23, v30
s_waitcnt lgkmcnt(0)
v_sub_f32 v23, v23, v6
v_exp_f32 v23, v23
v_add_u32 v30, 64, v30
v_add_f32 v7, v7, v23
v_cvt_pk_bf16_f32 v24, v23, 0
v_cvt_pk_bf16_f32 v25, 0, v23
v_readfirstlane_b32 s76, v37
s_and_b32 s3, s76, 7
s_cmp_eq_u32 s3, s45
s_cbranch_scc1 L_samev2
s_mov_b32 s45, s3
s_cmp_eq_u32 s3, 1
s_cselect_b32 s40, s8, s20
s_cselect_b32 s41, s9, s21
s_bitcmp0_b32 s3, 0
s_cselect_b32 s40, s18, s40
s_cselect_b32 s41, s19, s41
L_samev2:
s_and_b32 s3, s76, -8
v_add_u32 v36, s3, v1
s_waitcnt vmcnt(8)
v_dot2c_f32_bf16_dpp v8, v24, v72 quad_perm:[0,0,0,0] row_mask:0xf bank_mask:0xf
v_dot2c_f32_bf16_dpp v9, v25, v72 quad_perm:[0,0,0,0] row_mask:0xf bank_mask:0xf
v_dot2c_f32_bf16_dpp v10, v24, v73 quad_perm:[0,0,0,0] row_mask:0xf bank_mask:0xf
v_dot2c_f32_bf16_dpp v11, v25, v73 quad_perm:[0,0,0,0] row_mask:0xf bank_mask:0xf
v_dot2c_f32_bf16_dpp v12, v24, v74 quad_perm:[0,0,0,0] row_mask:0xf bank_mask:0xf
v_dot2c_f32_bf16_dpp v13, v25, v74 quad_perm:[0,0,0,0] row_mask:0xf bank_mask:0xf
v_dot2c_f32_bf16_dpp v14, v24, v75 quad_perm:[0,0,0,0] row_mask:0xf bank_mask:0xf
v_dot2c_f32_bf16_dpp v15, v25, v75 quad_perm:[0,0,0,0] row_mask:0xf bank_mask:0xf
v_dot2c_f32_bf16_dpp v8, v24, v76 quad_perm:[1,1,1,1] row_mask:0xf bank_mask:0xf
v_dot2c_f32_bf16_dpp v9, v25, v76 quad_perm:[1,1,1,1] row_mask:0xf bank_mask:0xf
v_dot2c_f32_bf16_dpp v10, v24, v77 quad_perm:[1,1,1,1] row_mask:0xf bank_mask:0xf
v_dot2c_f32_bf16_dpp v11, v25, v77 quad_perm:[1,1,1,1] row_mask:0xf bank_mask:0xf
v_dot2c_f32_bf16_dpp v12, v24, v78 quad_perm:[1,1,1,1] row_mask:0xf bank_mask:0xf
v_dot2c_f32_bf16_dpp v13, v25, v78 quad_perm:[1,1,1,1] row_mask:0xf bank_mask:0xf
v_dot2c_f32_bf16_dpp v14, v24, v79 quad_perm:[1,1,1,1] row_mask:0xf bank_mask:0xf
v_dot2c_f32_bf16_dpp v15, v25, v79 quad_perm:[1,1,1,1] row_mask:0xf bank_mask:0xf
v_dot2c_f32_bf16_dpp v8, v24, v80 quad_perm:[2,2,2,2] row_mask:0xf bank_mask:0xf
v_dot2c_f32_bf16_dpp v9, v25, v80 quad_perm:[2,2,2,2] row_mask:0xf bank_mask:0xf
v_dot2c_f32_bf16_dpp v10, v24, v81 quad_perm:[2,2,2,2] row_mask:0xf bank_mask:0xf
v_dot2c_f32_bf16_dpp v11, v25, v81 quad_perm:[2,2,2,2] row_mask:0xf bank_mask:0xf
v_dot2c_f32_bf16_dpp v12, v24, v82 quad_perm:[2,2,2,2] row_mask:0xf bank_mask:0xf
v_dot2c_f32_bf16_dpp v13, v25, v82 quad_perm:[2,2,2,2] row_mask:0xf bank_mask:0xf
v_dot2c_f32_bf16_dpp v14, v24, v83 quad_perm:[2,2,2,2] row_mask:0xf bank_mask:0xf
v_dot2c_f32_bf16_dpp v15, v25, v83 quad_perm:[2,2,2,2] row_mask:0xf bank_mask:0xf
v_dot2c_f32_bf16_dpp v8, v24, v84 quad_perm:[3,3,3,3] row_mask:0xf bank_mask:0xf
v_dot2c_f32_bf16_dpp v9, v25, v84 quad_perm:[3,3,3,3] row_mask:0xf bank_mask:0xf
v_dot2c_f32_bf16_dpp v10, v24, v85 quad_perm:[3,3,3,3] row_mask:0xf bank_mask:0xf
v_dot2c_f32_bf16_dpp v11, v25, v85 quad_perm:[3,3,3,3] row_mask:0xf bank_mask:0xf
v_dot2c_f32_bf16_dpp v12, v24, v86 quad_perm:[3,3,3,3] row_mask:0xf bank_mask:0xf
v_dot2c_f32_bf16_dpp v13, v25, v86 quad_perm:[3,3,3,3] row_mask:0xf bank_mask:0xf
v_dot2c_f32_bf16_dpp v14, v24, v87 quad_perm:[3,3,3,3] row_mask:0xf bank_mask:0xf
v_dot2c_f32_bf16_dpp v15, v25, v87 quad_perm:[3,3,3,3] row_mask:0xf bank_mask:0xf
buffer_load_dwordx4 v[72:75], v36, s[40:43], 0 offen offset:0 nt
buffer_load_dwordx4 v[76:79], v36, s[40:43], 0 offen offset:1024 nt
buffer_load_dwordx4 v[80:83], v36, s[40:43], 0 offen offset:2048 nt
buffer_load_dwordx4 v[84:87], v36, s[40:43], 0 offen offset:3072 nt
s_branch L_tail2
L_pair2:
s_bitcmp1_b32 s44, 0
s_cbranch_scc1 L_pv2
s_waitcnt vmcnt(8)
v_dot2_f32_bf16 v16, v72, v2, 0
v_dot2_f32_bf16 v17, v76, v2, 0
v_dot2_f32_bf16 v18, v80, v2, 0
v_dot2_f32_bf16 v19, v84, v2, 0
v_dot2_f32_bf16 v16, v73, v3, v16
v_dot2_f32_bf16 v17, v77, v3, v17
v_dot2_f32_bf16 v18, v81, v3, v18
v_dot2_f32_bf16 v19, v85, v3, v19
v_dot2_f32_bf16 v16, v74, v4, v16
v_dot2_f32_bf16 v17, v78, v4, v17
v_dot2_f32_bf16 v18, v82, v4, v18
v_dot2_f32_bf16 v19, v86, v4, v19
v_dot2_f32_bf16 v16, v75, v5, v16
v_dot2_f32_bf16 v17, v79, v5, v17
v_dot2_f32_bf16 v18, v83, v5, v18
v_dot2_f32_bf16 v19, v87, v5, v19
s_waitcnt lgkmcnt(0)
v_readfirstlane_b32 s76, v37
s_and_b32 s3, s76, 7
s_cmp_eq_u32 s3, s45
s_cbranch_scc1 L_sameo2
s_mov_b32 s45, s3
s_cmp_eq_u32 s3, 1
s_cselect_b32 s40, s8, s20
s_cselect_b32 s41, s9, s21
s_bitcmp0_b32 s3, 0
s_cselect_b32 s40, s18, s40
s_cselect_b32 s41, s19, s41
L_sameo2:
s_and_b32 s3, s76, -8
v_add_u32 v36, s3, v1
v_add_f32_dpp v20, v16, v16 quad_perm:[1,0,3,2] row_mask:0xf bank_mask:0xf
v_add_f32_dpp v21, v17, v17 quad_perm:[1,0,3,2] row_mask:0xf bank_mask:0xf
v_add_f32_dpp v22, v18, v18 quad_perm:[1,0,3,2] row_mask:0xf bank_mask:0xf
v_add_f32_dpp v23, v19, v19 quad_perm:[1,0,3,2] row_mask:0xf bank_mask:0xf
buffer_load_dwordx4 v[72:75], v36, s[40:43], 0 offen offset:0 nt
buffer_load_dwordx4 v[76:79], v36, s[40:43], 0 offen offset:1024 nt
buffer_load_dwordx4 v[80:83], v36, s[40:43], 0 offen offset:2048 nt
buffer_load_dwordx4 v[84:87], v36, s[40:43], 0 offen offset:3072 nt
v_cndmask_b32 v20, v20, v21, s[80:81]
v_cndmask_b32 v22, v22, v23, s[80:81]
s_nop 0
v_add_f32_dpp v20, v20, v20 quad_perm:[2,3,0,1] row_mask:0xf bank_mask:0xf
v_add_f32_dpp v22, v22, v22 quad_perm:[2,3,0,1] row_mask:0xf bank_mask:0xf
v_cndmask_b32 v20, v20, v22, s[82:83]
s_nop 1
v_add_f32_dpp v20, v20, v20 row_ror:4 row_mask:0xf bank_mask:0xf
s_nop 1
v_add_f32_dpp v20, v20, v20 row_ror:8 row_mask:0xf bank_mask:0xf
v_mul_f32 v20, s84, v20
s_nop 1
v_max_f32_dpp v21, v20, v20 quad_perm:[1,0,3,2] row_mask:0xf bank_mask:0xf
s_nop 1
v_max_f32_dpp v21, v21, v21 quad_perm:[2,3,0,1] row_mask:0xf bank_mask:0xf
v_max_f32 v21, v21, v6
v_sub_f32 v22, v6, v21
v_sub_f32 v23, v20, v21
v_exp_f32 v22, v22
v_exp_f32 v23, v23
v_mov_b32 v6, v21
v_fma_f32 v7, v7, v22, v23
v_cvt_pk_bf16_f32 v24, v23, 0
v_cvt_pk_bf16_f32 v25, 0, v23
v_mul_f32 v8, v8, v22
v_mul_f32 v9, v9, v22
v_mul_f32 v10, v10, v22
v_mul_f32 v11, v11, v22
v_mul_f32 v12, v12, v22
v_mul_f32 v13, v13, v22
v_mul_f32 v14, v14, v22
v_mul_f32 v15, v15, v22
s_branch L_tail2
L_pv2:
s_waitcnt lgkmcnt(0)
v_readfirstlane_b32 s76, v37
s_and_b32 s3, s76, 7
s_cmp_eq_u32 s3, s45
s_cbranch_scc1 L_samed2
s_mov_b32 s45, s3
s_cmp_eq_u32 s3, 1
s_cselect_b32 s40, s8, s20
s_cselect_b32 s41, s9, s21
s_bitcmp0_b32 s3, 0
s_cselect_b32 s40, s18, s40
s_cselect_b32 s41, s19, s41
L_samed2:
s_and_b32 s3, s76, -8
v_add_u32 v36, s3, v1
s_waitcnt vmcnt(8)
v_dot2c_f32_bf16_dpp v8, v24, v72 quad_perm:[0,0,0,0] row_mask:0xf bank_mask:0xf
v_dot2c_f32_bf16_dpp v9, v25, v72 quad_perm:[0,0,0,0] row_mask:0xf bank_mask:0xf
v_dot2c_f32_bf16_dpp v10, v24, v73 quad_perm:[0,0,0,0] row_mask:0xf bank_mask:0xf
v_dot2c_f32_bf16_dpp v11, v25, v73 quad_perm:[0,0,0,0] row_mask:0xf bank_mask:0xf
v_dot2c_f32_bf16_dpp v12, v24, v74 quad_perm:[0,0,0,0] row_mask:0xf bank_mask:0xf
v_dot2c_f32_bf16_dpp v13, v25, v74 quad_perm:[0,0,0,0] row_mask:0xf bank_mask:0xf
v_dot2c_f32_bf16_dpp v14, v24, v75 quad_perm:[0,0,0,0] row_mask:0xf bank_mask:0xf
v_dot2c_f32_bf16_dpp v15, v25, v75 quad_perm:[0,0,0,0] row_mask:0xf bank_mask:0xf
v_dot2c_f32_bf16_dpp v8, v24, v76 quad_perm:[1,1,1,1] row_mask:0xf bank_mask:0xf
v_dot2c_f32_bf16_dpp v9, v25, v76 quad_perm:[1,1,1,1] row_mask:0xf bank_mask:0xf
v_dot2c_f32_bf16_dpp v10, v24, v77 quad_perm:[1,1,1,1] row_mask:0xf bank_mask:0xf
v_dot2c_f32_bf16_dpp v11, v25, v77 quad_perm:[1,1,1,1] row_mask:0xf bank_mask:0xf
v_dot2c_f32_bf16_dpp v12, v24, v78 quad_perm:[1,1,1,1] row_mask:0xf bank_mask:0xf
v_dot2c_f32_bf16_dpp v13, v25, v78 quad_perm:[1,1,1,1] row_mask:0xf bank_mask:0xf
v_dot2c_f32_bf16_dpp v14, v24, v79 quad_perm:[1,1,1,1] row_mask:0xf bank_mask:0xf
v_dot2c_f32_bf16_dpp v15, v25, v79 quad_perm:[1,1,1,1] row_mask:0xf bank_mask:0xf
v_dot2c_f32_bf16_dpp v8, v24, v80 quad_perm:[2,2,2,2] row_mask:0xf bank_mask:0xf
v_dot2c_f32_bf16_dpp v9, v25, v80 quad_perm:[2,2,2,2] row_mask:0xf bank_mask:0xf
v_dot2c_f32_bf16_dpp v10, v24, v81 quad_perm:[2,2,2,2] row_mask:0xf bank_mask:0xf
v_dot2c_f32_bf16_dpp v11, v25, v81 quad_perm:[2,2,2,2] row_mask:0xf bank_mask:0xf
v_dot2c_f32_bf16_dpp v12, v24, v82 quad_perm:[2,2,2,2] row_mask:0xf bank_mask:0xf
v_dot2c_f32_bf16_dpp v13, v25, v82 quad_perm:[2,2,2,2] row_mask:0xf bank_mask:0xf
v_dot2c_f32_bf16_dpp v14, v24, v83 quad_perm:[2,2,2,2] row_mask:0xf bank_mask:0xf
v_dot2c_f32_bf16_dpp v15, v25, v83 quad_perm:[2,2,2,2] row_mask:0xf bank_mask:0xf
v_dot2c_f32_bf16_dpp v8, v24, v84 quad_perm:[3,3,3,3] row_mask:0xf bank_mask:0xf
v_dot2c_f32_bf16_dpp v9, v25, v84 quad_perm:[3,3,3,3] row_mask:0xf bank_mask:0xf
v_dot2c_f32_bf16_dpp v10, v24, v85 quad_perm:[3,3,3,3] row_mask:0xf bank_mask:0xf
v_dot2c_f32_bf16_dpp v11, v25, v85 quad_perm:[3,3,3,3] row_mask:0xf bank_mask:0xf
v_dot2c_f32_bf16_dpp v12, v24, v86 quad_perm:[3,3,3,3] row_mask:0xf bank_mask:0xf
v_dot2c_f32_bf16_dpp v13, v25, v86 quad_perm:[3,3,3,3] row_mask:0xf bank_mask:0xf
v_dot2c_f32_bf16_dpp v14, v24, v87 quad_perm:[3,3,3,3] row_mask:0xf bank_mask:0xf
v_dot2c_f32_bf16_dpp v15, v25, v87 quad_perm:[3,3,3,3] row_mask:0xf bank_mask:0xf
buffer_load_dwordx4 v[72:75], v36, s[40:43], 0 offen offset:0 nt
buffer_load_dwordx4 v[76:79], v36, s[40:43], 0 offen offset:1024 nt
buffer_load_dwordx4 v[80:83], v36, s[40:43], 0 offen offset:2048 nt
buffer_load_dwordx4 v[84:87], v36, s[40:43], 0 offen offset:3072 nt
L_tail2:
s_mov_b32 s74, s76
s_barrier
s_branch L_loop
L_done:
s_nop 2
v_add_f32_dpp v7, v7, v7 quad_perm:[1,0,3,2] row_mask:0xf bank_mask:0xf
v_mov_b32 v20, v6
s_nop 0
v_add_f32_dpp v7, v7, v7 quad_perm:[2,3,0,1] row_mask:0xf bank_mask:0xf
v_mov_b32 v21, v20
s_nop 1
v_permlane32_swap_b32 v20, v21
v_max_f32 v20, v20, v21
v_mov_b32 v21, v20
s_nop 1
v_permlane16_swap_b32 v20, v21
v_max_f32 v20, v20, v21
v_sub_f32 v22, v6, v20
v_exp_f32 v22, v22
s_nop 0
v_mul_f32 v7, v7, v22
v_mul_f32 v8, v8, v22
v_mul_f32 v9, v9, v22
v_mul_f32 v10, v10, v22
v_mul_f32 v11, v11, v22
v_mul_f32 v12, v12, v22
v_mul_f32 v13, v13, v22
v_mul_f32 v14, v14, v22
v_mul_f32 v15, v15, v22
v_mov_b32 v21, v7
s_nop 1
v_permlane32_swap_b32 v7, v21
v_add_f32 v7, v7, v21
v_mov_b32 v21, v7
s_nop 1
v_permlane16_swap_b32 v7, v21
v_add_f32 v7, v7, v21
v_permlane32_swap_b32 v8, v9
v_permlane32_swap_b32 v10, v11
v_permlane32_swap_b32 v12, v13
v_permlane32_swap_b32 v14, v15
v_add_f32 v8, v8, v9
v_add_f32 v10, v10, v11
v_add_f32 v12, v12, v13
v_add_f32 v14, v14, v15
v_permlane16_swap_b32 v8, v10
s_nop 0
v_permlane16_swap_b32 v12, v14
v_add_f32 v8, v8, v10
v_add_f32 v12, v12, v14
v_add_u32 v23, 4864, v35
ds_write2_b32 v23, v8, v12 offset0:0 offset1:4
v_mov_b32 v21, v7
s_lshl_b32 s3, s38, 3
v_mov_b32 v24, s3
ds_write_b64 v24, v[20:21] offset:6912
v_lshrrev_b32 v20, 4, v32
v_lshlrev_b32 v20, 3, v20
v_and_b32 v21, 7, v32
v_add_u32 v20, v20, v21
s_lshl_b32 s3, s38, 5
v_add_u32 v20, s3, v20
v_lshlrev_b32 v20, 1, v20
s_waitcnt lgkmcnt(0)
s_barrier
v_mov_b32 v8, 0
v_mov_b32 v9, 0
v_mov_b32 v10, 0
v_mov_b32 v11, 0
v_mov_b32 v12, 0
v_mov_b32 v13, 0
v_mov_b32 v14, 0
v_mov_b32 v15, 0
s_barrier
ds_read_u16 v24, v20 offset:7168
s_waitcnt lgkmcnt(0)
v_lshlrev_b32 v25, 16, v24
v_dot2c_f32_bf16_dpp v8, v24, v88 row_newbcast:0 row_mask:0xf bank_mask:0xf
s_nop 0
v_dot2c_f32_bf16_dpp v9, v25, v88 row_newbcast:0 row_mask:0xf bank_mask:0xf
v_dot2c_f32_bf16_dpp v10, v24, v89 row_newbcast:0 row_mask:0xf bank_mask:0xf
v_dot2c_f32_bf16_dpp v11, v25, v89 row_newbcast:0 row_mask:0xf bank_mask:0xf
v_dot2c_f32_bf16_dpp v12, v24, v90 row_newbcast:0 row_mask:0xf bank_mask:0xf
v_dot2c_f32_bf16_dpp v13, v25, v90 row_newbcast:0 row_mask:0xf bank_mask:0xf
v_dot2c_f32_bf16_dpp v14, v24, v91 row_newbcast:0 row_mask:0xf bank_mask:0xf
v_dot2c_f32_bf16_dpp v15, v25, v91 row_newbcast:0 row_mask:0xf bank_mask:0xf
v_dot2c_f32_bf16_dpp v8, v24, v92 row_newbcast:1 row_mask:0xf bank_mask:0xf
v_dot2c_f32_bf16_dpp v9, v25, v92 row_newbcast:1 row_mask:0xf bank_mask:0xf
v_dot2c_f32_bf16_dpp v10, v24, v93 row_newbcast:1 row_mask:0xf bank_mask:0xf
v_dot2c_f32_bf16_dpp v11, v25, v93 row_newbcast:1 row_mask:0xf bank_mask:0xf
v_dot2c_f32_bf16_dpp v12, v24, v94 row_newbcast:1 row_mask:0xf bank_mask:0xf
v_dot2c_f32_bf16_dpp v13, v25, v94 row_newbcast:1 row_mask:0xf bank_mask:0xf
v_dot2c_f32_bf16_dpp v14, v24, v95 row_newbcast:1 row_mask:0xf bank_mask:0xf
v_dot2c_f32_bf16_dpp v15, v25, v95 row_newbcast:1 row_mask:0xf bank_mask:0xf
v_dot2c_f32_bf16_dpp v8, v24, v96 row_newbcast:2 row_mask:0xf bank_mask:0xf
v_dot2c_f32_bf16_dpp v9, v25, v96 row_newbcast:2 row_mask:0xf bank_mask:0xf
v_dot2c_f32_bf16_dpp v10, v24, v97 row_newbcast:2 row_mask:0xf bank_mask:0xf
v_dot2c_f32_bf16_dpp v11, v25, v97 row_newbcast:2 row_mask:0xf bank_mask:0xf
v_dot2c_f32_bf16_dpp v12, v24, v98 row_newbcast:2 row_mask:0xf bank_mask:0xf
v_dot2c_f32_bf16_dpp v13, v25, v98 row_newbcast:2 row_mask:0xf bank_mask:0xf
v_dot2c_f32_bf16_dpp v14, v24, v99 row_newbcast:2 row_mask:0xf bank_mask:0xf
v_dot2c_f32_bf16_dpp v15, v25, v99 row_newbcast:2 row_mask:0xf bank_mask:0xf
v_dot2c_f32_bf16_dpp v8, v24, v100 row_newbcast:3 row_mask:0xf bank_mask:0xf
v_dot2c_f32_bf16_dpp v9, v25, v100 row_newbcast:3 row_mask:0xf bank_mask:0xf
v_dot2c_f32_bf16_dpp v10, v24, v101 row_newbcast:3 row_mask:0xf bank_mask:0xf
v_dot2c_f32_bf16_dpp v11, v25, v101 row_newbcast:3 row_mask:0xf bank_mask:0xf
v_dot2c_f32_bf16_dpp v12, v24, v102 row_newbcast:3 row_mask:0xf bank_mask:0xf
v_dot2c_f32_bf16_dpp v13, v25, v102 row_newbcast:3 row_mask:0xf bank_mask:0xf
v_dot2c_f32_bf16_dpp v14, v24, v103 row_newbcast:3 row_mask:0xf bank_mask:0xf
v_dot2c_f32_bf16_dpp v15, v25, v103 row_newbcast:3 row_mask:0xf bank_mask:0xf
v_dot2c_f32_bf16_dpp v8, v24, v104 row_newbcast:4 row_mask:0xf bank_mask:0xf
v_dot2c_f32_bf16_dpp v9, v25, v104 row_newbcast:4 row_mask:0xf bank_mask:0xf
v_dot2c_f32_bf16_dpp v10, v24, v105 row_newbcast:4 row_mask:0xf bank_mask:0xf
v_dot2c_f32_bf16_dpp v11, v25, v105 row_newbcast:4 row_mask:0xf bank_mask:0xf
v_dot2c_f32_bf16_dpp v12, v24, v106 row_newbcast:4 row_mask:0xf bank_mask:0xf
v_dot2c_f32_bf16_dpp v13, v25, v106 row_newbcast:4 row_mask:0xf bank_mask:0xf
v_dot2c_f32_bf16_dpp v14, v24, v107 row_newbcast:4 row_mask:0xf bank_mask:0xf
v_dot2c_f32_bf16_dpp v15, v25, v107 row_newbcast:4 row_mask:0xf bank_mask:0xf
v_dot2c_f32_bf16_dpp v8, v24, v108 row_newbcast:5 row_mask:0xf bank_mask:0xf
v_dot2c_f32_bf16_dpp v9, v25, v108 row_newbcast:5 row_mask:0xf bank_mask:0xf
v_dot2c_f32_bf16_dpp v10, v24, v109 row_newbcast:5 row_mask:0xf bank_mask:0xf
v_dot2c_f32_bf16_dpp v11, v25, v109 row_newbcast:5 row_mask:0xf bank_mask:0xf
v_dot2c_f32_bf16_dpp v12, v24, v110 row_newbcast:5 row_mask:0xf bank_mask:0xf
v_dot2c_f32_bf16_dpp v13, v25, v110 row_newbcast:5 row_mask:0xf bank_mask:0xf
v_dot2c_f32_bf16_dpp v14, v24, v111 row_newbcast:5 row_mask:0xf bank_mask:0xf
v_dot2c_f32_bf16_dpp v15, v25, v111 row_newbcast:5 row_mask:0xf bank_mask:0xf
v_dot2c_f32_bf16_dpp v8, v24, v112 row_newbcast:6 row_mask:0xf bank_mask:0xf
v_dot2c_f32_bf16_dpp v9, v25, v112 row_newbcast:6 row_mask:0xf bank_mask:0xf
v_dot2c_f32_bf16_dpp v10, v24, v113 row_newbcast:6 row_mask:0xf bank_mask:0xf
v_dot2c_f32_bf16_dpp v11, v25, v113 row_newbcast:6 row_mask:0xf bank_mask:0xf
v_dot2c_f32_bf16_dpp v12, v24, v114 row_newbcast:6 row_mask:0xf bank_mask:0xf
v_dot2c_f32_bf16_dpp v13, v25, v114 row_newbcast:6 row_mask:0xf bank_mask:0xf
v_dot2c_f32_bf16_dpp v14, v24, v115 row_newbcast:6 row_mask:0xf bank_mask:0xf
v_dot2c_f32_bf16_dpp v15, v25, v115 row_newbcast:6 row_mask:0xf bank_mask:0xf
v_dot2c_f32_bf16_dpp v8, v24, v116 row_newbcast:7 row_mask:0xf bank_mask:0xf
v_dot2c_f32_bf16_dpp v9, v25, v116 row_newbcast:7 row_mask:0xf bank_mask:0xf
v_dot2c_f32_bf16_dpp v10, v24, v117 row_newbcast:7 row_mask:0xf bank_mask:0xf
v_dot2c_f32_bf16_dpp v11, v25, v117 row_newbcast:7 row_mask:0xf bank_mask:0xf
v_dot2c_f32_bf16_dpp v12, v24, v118 row_newbcast:7 row_mask:0xf bank_mask:0xf
v_dot2c_f32_bf16_dpp v13, v25, v118 row_newbcast:7 row_mask:0xf bank_mask:0xf
v_dot2c_f32_bf16_dpp v14, v24, v119 row_newbcast:7 row_mask:0xf bank_mask:0xf
v_dot2c_f32_bf16_dpp v15, v25, v119 row_newbcast:7 row_mask:0xf bank_mask:0xf
v_permlane32_swap_b32 v8, v9
v_permlane32_swap_b32 v10, v11
v_permlane32_swap_b32 v12, v13
v_permlane32_swap_b32 v14, v15
v_add_f32 v8, v8, v9
v_add_f32 v10, v10, v11
v_add_f32 v12, v12, v13
v_add_f32 v14, v14, v15
v_permlane16_swap_b32 v8, v10
s_nop 0
v_permlane16_swap_b32 v12, v14
v_add_f32 v8, v8, v10
v_add_f32 v12, v12, v14
v_add_u32 v23, 7424, v35
ds_write2_b32 v23, v8, v12 offset0:0 offset1:4
s_waitcnt lgkmcnt(0)
s_barrier
s_endpgm
L_ctl:
s_setprio 3
s_waitcnt lgkmcnt(0)
s_mov_b32 s48, s70
s_mov_b32 s49, s71
s_mov_b32 s50, 2097152
s_mov_b32 s51, 0x20000
s_mov_b32 s56, s30
s_mov_b32 s57, s31
s_mov_b32 s58, 256
s_mov_b32 s59, 0x20000
v_mov_b32 v20, -1
v_mov_b32 v21, -1
v_mov_b32 v22, -1
v_mov_b32 v23, -1
v_lshlrev_b32 v26, 3, v32
s_lshl_b32 s3, s79, 9
s_add_u32 s16, s3, 1703936
buffer_store_dwordx2 v[20:21], v26, s[48:51], s16 offen sc1
s_add_u32 s16, s3, 1572864
buffer_store_dwordx2 v[20:21], v26, s[48:51], s16 offen sc1
s_lshl_b32 s3, s2, 11
s_add_u32 s16, s3, 1048576
buffer_store_dwordx2 v[20:21], v26, s[48:51], s16 offen sc1
buffer_store_dwordx2 v[20:21], v26, s[48:51], s16 offen offset:1024 sc1
buffer_store_dwordx2 v[20:21], v38, s[48:51], s16 offen offset:512 sc1
buffer_store_dwordx2 v[20:21], v38, s[48:51], s16 offen offset:1536 sc1
s_cmp_lg_u32 s33, 0
s_cbranch_scc1 L_nocnt
v_mov_b32 v24, 1572864
s_lshl_b32 s3, s37, 9
s_add_u32 s3, s3, 1835008
buffer_store_dword v24, v38, s[48:51], s3 offen sc1
L_nocnt:
s_mov_b32 s68, s28
s_mov_b32 s69, s29
s_mov_b32 s70, 2048
s_mov_b32 s71, 0x20000
s_waitcnt vmcnt(0)
s_mov_b64 exec, 1
v_mov_b32 v20, 1
s_lshl_b32 s3, s37, 3
buffer_atomic_add v20, v38, s[56:59], s3 offen offset:0 sc1
s_mov_b64 exec, -1
s_barrier
s_barrier
ds_read_b64 v[40:41], v26 offset:0
ds_read_b64 v[42:43], v26 offset:512
ds_read_b64 v[44:45], v26 offset:1024
ds_read_b64 v[46:47], v26 offset:1536
s_waitcnt lgkmcnt(0)
v_add_f32 v40, v40, v42
v_add_f32 v41, v41, v43
v_add_f32 v44, v44, v46
v_add_f32 v45, v45, v47
v_add_f32 v40, v40, v44
v_add_f32 v41, v41, v45
v_min_u32 v40, -2, v40
v_min_u32 v41, -2, v41
s_lshl_b32 s3, s79, 9
s_add_u32 s3, s3, 1703936
buffer_store_dwordx2 v[40:41], v26, s[48:51], s3 offen sc1
s_lshl_b32 s3, s37, 3
buffer_load_dword v39, v38, s[56:59], s3 offen offset:0 sc1
s_waitcnt vmcnt(0)
L_flag:
v_readfirstlane_b32 s3, v39
s_cmp_ge_u32 s3, 8
s_cbranch_scc1 L_flagok
s_lshl_b32 s3, s37, 3
s_nop 1
buffer_load_dword v39, v38, s[56:59], s3 offen offset:0 sc1
s_waitcnt vmcnt(0)
s_sub_u32 s85, s85, 1
s_cmp_gt_i32 s85, 0
s_cbranch_scc1 L_flag
L_flagok:
s_lshl_b32 s16, s37, 11
s_add_u32 s16, s16, 1703936
s_add_u32 s22, s16, 65536
L_pollq:
buffer_load_dwordx2 v[40:41], v26, s[48:51], s16 offen offset:0 sc1
buffer_load_dwordx2 v[42:43], v26, s[48:51], s16 offen offset:512 sc1
buffer_load_dwordx2 v[44:45], v26, s[48:51], s16 offen offset:1024 sc1
buffer_load_dwordx2 v[46:47], v26, s[48:51], s16 offen offset:1536 sc1
s_waitcnt vmcnt(0)
v_max3_u32 v22, v40, v41, v42
v_max3_u32 v22, v22, v43, v44
v_max3_u32 v22, v22, v45, v46
v_max_u32 v22, v22, v47
v_cmp_eq_u32 vcc, -1, v22
s_cmp_lg_u64 vcc, 0
s_cbranch_scc0 L_gotq
s_sub_u32 s85, s85, 1
s_cmp_gt_i32 s85, 0
s_cbranch_scc1 L_pollq
L_gotq:
buffer_load_dwordx2 v[48:49], v26, s[48:51], s22 offen offset:0 sc1
buffer_load_dwordx2 v[50:51], v26, s[48:51], s22 offen offset:512 sc1
buffer_load_dwordx2 v[52:53], v26, s[48:51], s22 offen offset:1024 sc1
buffer_load_dwordx2 v[54:55], v26, s[48:51], s22 offen offset:1536 sc1
v_and_b32 v20, 31, v32
v_lshlrev_b32 v20, 3, v20
buffer_load_dword v29, v20, s[56:59], 0 offen offset:0 sc1
v_add_f32 v40, v40, v42
v_add_f32 v41, v41, v43
v_add_f32 v44, v44, v46
v_add_f32 v45, v45, v47
v_add_f32 v40, v40, v44
v_add_f32 v41, v41, v45
v_cvt_pk_bf16_f32 v40, v40, v41
v_lshlrev_b32 v21, 2, v32
ds_write_b32 v21, v40 offset:2048
s_mul_i32 s62, s33, 524288
s_add_u32 s3, s62, 212992
v_mov_b32 v28, s3
ds_write_b32 v38, v28 offset:9472
s_waitcnt lgkmcnt(0)
s_barrier
s_waitcnt vmcnt(0)
L_qb:
v_max3_u32 v22, v48, v49, v50
v_max3_u32 v22, v22, v51, v52
v_max3_u32 v22, v22, v53, v54
v_max_u32 v22, v22, v55
v_cmp_eq_u32 vcc, -1, v22
s_cmp_lg_u64 vcc, 0
s_cbranch_scc0 L_qbok
buffer_load_dwordx2 v[48:49], v26, s[48:51], s22 offen offset:0 sc1
buffer_load_dwordx2 v[50:51], v26, s[48:51], s22 offen offset:512 sc1
buffer_load_dwordx2 v[52:53], v26, s[48:51], s22 offen offset:1024 sc1
buffer_load_dwordx2 v[54:55], v26, s[48:51], s22 offen offset:1536 sc1
s_waitcnt vmcnt(0)
s_sub_u32 s85, s85, 1
s_cmp_gt_i32 s85, 0
s_cbranch_scc1 L_qb
L_qbok:
v_add_f32 v48, v48, v50
v_add_f32 v49, v49, v51
v_add_f32 v52, v52, v54
v_add_f32 v53, v53, v55
v_add_f32 v48, v48, v52
v_add_f32 v49, v49, v53
v_cvt_pk_bf16_f32 v48, v48, v49
v_lshlrev_b32 v21, 2, v32
ds_write_b32 v21, v48 offset:2304
L_rc:
v_cmp_gt_u32 vcc, 8, v29
s_cmp_lg_u64 vcc, 0
s_cbranch_scc0 L_rcok
v_and_b32 v20, 31, v32
v_lshlrev_b32 v20, 3, v20
buffer_load_dword v29, v20, s[56:59], 0 offen offset:0 sc1
s_waitcnt vmcnt(0)
s_sub_u32 s85, s85, 1
s_cmp_gt_i32 s85, 0
s_cbranch_scc1 L_rc
L_rcok:
s_mov_b32 s40, 14
s_mov_b32 s41, 0
s_mov_b32 s23, 0
s_mov_b32 s43, 10
s_mov_b32 s45, 0
s_mov_b32 s46, 1572864
s_mov_b32 s67, 0
s_mov_b32 s47, -4
s_mov_b32 s63, 0
s_mov_b32 s64, 0
s_lshl_b32 s60, s37, 9
s_add_u32 s60, s60, 1835008
s_mov_b32 s61, 4
s_mov_b32 s42, 32
s_mov_b32 s24, 12
s_sub_u32 s24, s24, 8
L_cloop:
s_cmp_lt_u32 s40, s42
s_cbranch_scc1 L_cgo
s_add_u32 s41, s41, 1
s_mov_b32 s40, 0
s_cmp_eq_u32 s41, 4
s_cbranch_scc1 L_cpairs
s_mov_b32 s23, s41
s_cmp_lg_u32 s41, 2
s_cbranch_scc1 L_cgo
s_mov_b32 s42, 12
s_mul_i32 s62, s33, 196608
L_cgo:
s_cmp_lg_u32 s41, 3
s_cbranch_scc1 L_cfix
s_cmp_eq_u32 s40, s24
s_cbranch_scc1 L_cpairs
L_cfix:
s_mul_i32 s3, s40, 16384
s_add_u32 s16, s62, s3
s_or_b32 s16, s16, s23
s_add_u32 s40, s40, 1
v_mov_b32 v27, s61
v_mov_b32 v28, s16
ds_write_b32 v27, v28 offset:9472
s_add_u32 s61, s61, 4
s_cmp_eq_u32 s61, 12
s_cselect_b32 s61, 0, s61
s_add_u32 s43, s43, 1
s_waitcnt lgkmcnt(0)
s_barrier
s_branch L_cloop
L_cpairs:
L_ploop:
s_cmp_lt_i32 s47, -2
s_cbranch_scc1 L_nohd0
s_waitcnt vmcnt(1)
v_readfirstlane_b32 s3, v30
s_add_u32 s45, s45, 16384
s_cmp_eq_u32 s63, 0
s_cbranch_scc1 L_norq0
s_mov_b32 s45, s3
s_add_u32 s3, s3, s65
L_norq0:
s_max_u32 s46, s46, s3
L_nohd0:
s_cmp_lt_i32 s47, 0
s_cbranch_scc1 L_pfix0
s_cmp_ge_u32 s45, 4194304
s_cbranch_scc1 L_cfin
s_or_b32 s16, s45, 4
s_branch L_pop0
L_pfix0:
s_mul_i32 s3, s40, 16384
s_add_u32 s16, s62, s3
s_or_b32 s16, s16, s23
s_add_u32 s40, s40, 1
L_pop0:
s_mov_b32 s63, 0
s_add_u32 s3, s47, 2
s_cmp_eq_u32 s3, s67
s_cbranch_scc1 L_take0
buffer_load_dword v30, v38, s[48:51], s60 offen sc1
s_branch L_pub0
L_take0:
s_min_u32 s3, s46, 4194304
s_sub_u32 s3, 4194304, s3
s_cmp_lg_u32 s3, 0
s_cbranch_scc1 L_ask0
v_mov_b32 v30, 4194304
s_mov_b32 s63, 1
s_mov_b32 s65, 0
s_add_u32 s67, s67, 1
buffer_load_dword v39, v38, s[48:51], s60 offen sc1
s_branch L_pub0
L_ask0:
s_lshr_b32 s3, s3, 18
s_max_u32 s3, s3, 1
s_min_u32 s3, s3, 64
s_add_u32 s67, s67, s3
s_lshl_b32 s65, s3, 14
s_mov_b32 s63, 1
v_mov_b32 v30, s65
s_mov_b64 exec, 1
buffer_atomic_add v30, v38, s[48:51], s60 offen sc0 sc1
s_mov_b64 exec, -1
L_pub0:
v_mov_b32 v27, s61
v_mov_b32 v28, s16
ds_write_b32 v27, v28 offset:9472
s_add_u32 s61, s61, 4
s_cmp_eq_u32 s61, 12
s_cselect_b32 s61, 0, s61
s_add_u32 s43, s43, 1
s_waitcnt lgkmcnt(0)
s_barrier
s_cmp_lt_i32 s47, 0
s_cbranch_scc1 L_pfixb0
s_or_b32 s16, s45, 5
s_branch L_pubb0
L_pfixb0:
s_mul_i32 s3, s40, 16384
s_add_u32 s16, s62, s3
s_or_b32 s16, s16, s23
s_add_u32 s40, s40, 1
L_pubb0:
v_mov_b32 v27, s61
v_mov_b32 v28, s16
ds_write_b32 v27, v28 offset:9472
s_add_u32 s61, s61, 4
s_cmp_eq_u32 s61, 12
s_cselect_b32 s61, 0, s61
s_add_u32 s43, s43, 1
s_waitcnt lgkmcnt(0)
s_barrier
s_add_u32 s47, s47, 1
s_cmp_lt_i32 s47, -2
s_cbranch_scc1 L_nohd1
s_waitcnt vmcnt(1)
v_readfirstlane_b32 s3, v31
s_add_u32 s45, s45, 16384
s_cmp_eq_u32 s64, 0
s_cbranch_scc1 L_norq1
s_mov_b32 s45, s3
s_add_u32 s3, s3, s66
L_norq1:
s_max_u32 s46, s46, s3
L_nohd1:
s_cmp_lt_i32 s47, 0
s_cbranch_scc1 L_pfix1
s_cmp_ge_u32 s45, 4194304
s_cbranch_scc1 L_cfin
s_or_b32 s16, s45, 4
s_branch L_pop1
L_pfix1:
s_mul_i32 s3, s40, 16384
s_add_u32 s16, s62, s3
s_or_b32 s16, s16, s23
s_add_u32 s40, s40, 1
L_pop1:
s_mov_b32 s64, 0
s_add_u32 s3, s47, 2
s_cmp_eq_u32 s3, s67
s_cbranch_scc1 L_take1
buffer_load_dword v31, v38, s[48:51], s60 offen sc1
s_branch L_pub1
L_take1:
s_min_u32 s3, s46, 4194304
s_sub_u32 s3, 4194304, s3
s_cmp_lg_u32 s3, 0
s_cbranch_scc1 L_ask1
v_mov_b32 v31, 4194304
s_mov_b32 s64, 1
s_mov_b32 s66, 0
s_add_u32 s67, s67, 1
buffer_load_dword v39, v38, s[48:51], s60 offen sc1
s_branch L_pub1
L_ask1:
s_lshr_b32 s3, s3, 18
s_max_u32 s3, s3, 1
s_min_u32 s3, s3, 64
s_add_u32 s67, s67, s3
s_lshl_b32 s66, s3, 14
s_mov_b32 s64, 1
v_mov_b32 v31, s66
s_mov_b64 exec, 1
buffer_atomic_add v31, v38, s[48:51], s60 offen sc0 sc1
s_mov_b64 exec, -1
L_pub1:
v_mov_b32 v27, s61
v_mov_b32 v28, s16
ds_write_b32 v27, v28 offset:9472
s_add_u32 s61, s61, 4
s_cmp_eq_u32 s61, 12
s_cselect_b32 s61, 0, s61
s_add_u32 s43, s43, 1
s_waitcnt lgkmcnt(0)
s_barrier
s_cmp_lt_i32 s47, 0
s_cbranch_scc1 L_pfixb1
s_or_b32 s16, s45, 5
s_branch L_pubb1
L_pfixb1:
s_mul_i32 s3, s40, 16384
s_add_u32 s16, s62, s3
s_or_b32 s16, s16, s23
s_add_u32 s40, s40, 1
L_pubb1:
v_mov_b32 v27, s61
v_mov_b32 v28, s16
ds_write_b32 v27, v28 offset:9472
s_add_u32 s61, s61, 4
s_cmp_eq_u32 s61, 12
s_cselect_b32 s61, 0, s61
s_add_u32 s43, s43, 1
s_waitcnt lgkmcnt(0)
s_barrier
s_add_u32 s47, s47, 1
s_branch L_ploop
L_cfin:
s_add_u32 s44, s43, 4
L_cend:
s_cmp_eq_u32 s43, s44
s_cbranch_scc1 L_cdone
s_mov_b32 s16, 4194309
v_mov_b32 v27, s61
v_mov_b32 v28, s16
ds_write_b32 v27, v28 offset:9472
s_add_u32 s61, s61, 4
s_cmp_eq_u32 s61, 12
s_cselect_b32 s61, 0, s61
s_add_u32 s43, s43, 1
s_waitcnt lgkmcnt(0)
s_barrier
s_branch L_cend
L_cdone:
ds_read_b64 v[40:41], v26 offset:2560
ds_read_b64 v[42:43], v26 offset:3072
ds_read_b64 v[44:45], v26 offset:3584
ds_read_b64 v[46:47], v26 offset:4096
ds_read_b64 v[48:49], v38 offset:4608
ds_read_b64 v[50:51], v38 offset:4616
ds_read_b64 v[52:53], v38 offset:4624
ds_read_b64 v[54:55], v38 offset:4632
s_waitcnt lgkmcnt(0)
v_max3_f32 v10, v48, v50, v52
v_max_f32 v10, v10, v54
v_sub_f32 v48, v48, v10
v_sub_f32 v50, v50, v10
v_sub_f32 v52, v52, v10
v_sub_f32 v54, v54, v10
v_exp_f32 v48, v48
v_exp_f32 v50, v50
v_exp_f32 v52, v52
v_exp_f32 v54, v54
v_mul_f32 v8, v40, v48
v_mul_f32 v9, v41, v48
v_mul_f32 v11, v49, v48
v_fmac_f32 v8, v42, v50
v_fmac_f32 v9, v43, v50
v_fmac_f32 v11, v51, v50
v_fmac_f32 v8, v44, v52
v_fmac_f32 v9, v45, v52
v_fmac_f32 v11, v53, v52
v_fmac_f32 v8, v46, v54
v_fmac_f32 v9, v47, v54
v_fmac_f32 v11, v55, v54
v_min_u32 v8, -2, v8
v_min_u32 v9, -2, v9
v_min_u32 v10, -2, v10
v_min_u32 v11, -2, v11
v_mov_b32 v12, v8
v_mov_b32 v13, v9
v_mov_b32 v14, v10
v_mov_b32 v15, v11
s_barrier
ds_read_b64 v[40:41], v26 offset:4864
ds_read_b64 v[42:43], v26 offset:5376
ds_read_b64 v[44:45], v26 offset:5888
ds_read_b64 v[46:47], v26 offset:6400
ds_read_b64 v[48:49], v38 offset:6912
ds_read_b64 v[50:51], v38 offset:6920
ds_read_b64 v[52:53], v38 offset:6928
ds_read_b64 v[54:55], v38 offset:6936
s_waitcnt lgkmcnt(0)
v_max3_f32 v10, v48, v50, v52
v_max_f32 v10, v10, v54
v_sub_f32 v48, v48, v10
v_sub_f32 v50, v50, v10
v_sub_f32 v52, v52, v10
v_sub_f32 v54, v54, v10
v_exp_f32 v48, v48
v_exp_f32 v50, v50
v_exp_f32 v52, v52
v_exp_f32 v54, v54
v_mul_f32 v8, v40, v48
v_mul_f32 v9, v41, v48
v_mul_f32 v11, v49, v48
v_fmac_f32 v8, v42, v50
v_fmac_f32 v9, v43, v50
v_fmac_f32 v11, v51, v50
v_fmac_f32 v8, v44, v52
v_fmac_f32 v9, v45, v52
v_fmac_f32 v11, v53, v52
v_fmac_f32 v8, v46, v54
v_fmac_f32 v9, v47, v54
v_fmac_f32 v11, v55, v54
v_min_u32 v8, -2, v8
v_min_u32 v9, -2, v9
v_min_u32 v10, -2, v10
v_min_u32 v11, -2, v11
s_lshl_b32 s3, s2, 11
s_add_u32 s3, s3, 1048576
buffer_store_dwordx2 v[8:9], v26, s[48:51], s3 offen offset:1024 sc1
buffer_store_dwordx2 v[10:11], v38, s[48:51], s3 offen offset:1536 sc1
buffer_store_dwordx2 v[12:13], v26, s[48:51], s3 offen sc1
buffer_store_dwordx2 v[14:15], v38, s[48:51], s3 offen offset:512 sc1
s_lshl_b32 s3, s37, 14
s_lshl_b32 s16, s36, 10
s_add_u32 s3, s3, s16
s_add_u32 s3, s3, 1048576
s_add_u32 s16, s3, 4096
s_add_u32 s17, s3, 8192
s_add_u32 s18, s3, 12288
v_and_b32 v20, 7, v32
v_lshlrev_b32 v20, 11, v20
L_poll1:
buffer_load_dwordx2 v[40:41], v26, s[48:51], s3 offen offset:0 sc1
buffer_load_dwordx2 v[42:43], v26, s[48:51], s3 offen offset:2048 sc1
buffer_load_dwordx2 v[44:45], v26, s[48:51], s16 offen offset:0 sc1
buffer_load_dwordx2 v[46:47], v26, s[48:51], s16 offen offset:2048 sc1
buffer_load_dwordx2 v[48:49], v26, s[48:51], s17 offen offset:0 sc1
buffer_load_dwordx2 v[50:51], v26, s[48:51], s17 offen offset:2048 sc1
buffer_load_dwordx2 v[52:53], v26, s[48:51], s18 offen offset:0 sc1
buffer_load_dwordx2 v[54:55], v26, s[48:51], s18 offen offset:2048 sc1
buffer_load_dwordx2 v[56:57], v20, s[48:51], s3 offen offset:512 sc1
s_waitcnt vmcnt(0)
v_max3_u32 v22, v40, v41, v42
v_max3_u32 v22, v22, v43, v44
v_max3_u32 v22, v22, v45, v46
v_max3_u32 v22, v22, v47, v48
v_max3_u32 v22, v22, v49, v50
v_max3_u32 v22, v22, v51, v52
v_max3_u32 v22, v22, v53, v54
v_max3_u32 v22, v22, v55, v56
v_max_u32 v22, v22, v57
v_cmp_eq_u32 vcc, -1, v22
s_cmp_lg_u64 vcc, 0
s_cbranch_scc0 L_got1
s_sub_u32 s85, s85, 1
s_cmp_gt_i32 s85, 0
s_cbranch_scc1 L_poll1
L_got1:
v_max_f32_dpp v21, v56, v56 quad_perm:[1,0,3,2] row_mask:0xf bank_mask:0xf
s_nop 1
v_max_f32_dpp v21, v21, v21 quad_perm:[2,3,0,1] row_mask:0xf bank_mask:0xf
s_nop 1
v_max_f32_dpp v21, v21, v21 row_ror:4 row_mask:0xf bank_mask:0xf
v_sub_f32 v21, v56, v21
v_exp_f32 v21, v21
v_mov_b32 v8, 0
v_mov_b32 v9, 0
v_mul_f32 v23, v57, v21
s_nop 1
v_add_f32_dpp v23, v23, v23 quad_perm:[1,0,3,2] row_mask:0xf bank_mask:0xf
s_nop 1
v_add_f32_dpp v23, v23, v23 quad_perm:[2,3,0,1] row_mask:0xf bank_mask:0xf
s_nop 1
v_add_f32_dpp v23, v23, v23 row_ror:4 row_mask:0xf bank_mask:0xf
v_fmac_f32_dpp v8, v21, v40 row_newbcast:0 row_mask:0xf bank_mask:0xf
v_fmac_f32_dpp v9, v21, v41 row_newbcast:0 row_mask:0xf bank_mask:0xf
s_nop 0
v_fmac_f32_dpp v8, v21, v42 row_newbcast:1 row_mask:0xf bank_mask:0xf
v_fmac_f32_dpp v9, v21, v43 row_newbcast:1 row_mask:0xf bank_mask:0xf
s_nop 0
v_fmac_f32_dpp v8, v21, v44 row_newbcast:2 row_mask:0xf bank_mask:0xf
v_fmac_f32_dpp v9, v21, v45 row_newbcast:2 row_mask:0xf bank_mask:0xf
s_nop 0
v_fmac_f32_dpp v8, v21, v46 row_newbcast:3 row_mask:0xf bank_mask:0xf
v_fmac_f32_dpp v9, v21, v47 row_newbcast:3 row_mask:0xf bank_mask:0xf
s_nop 0
v_fmac_f32_dpp v8, v21, v48 row_newbcast:4 row_mask:0xf bank_mask:0xf
v_fmac_f32_dpp v9, v21, v49 row_newbcast:4 row_mask:0xf bank_mask:0xf
s_nop 0
v_fmac_f32_dpp v8, v21, v50 row_newbcast:5 row_mask:0xf bank_mask:0xf
v_fmac_f32_dpp v9, v21, v51 row_newbcast:5 row_mask:0xf bank_mask:0xf
s_nop 0
v_fmac_f32_dpp v8, v21, v52 row_newbcast:6 row_mask:0xf bank_mask:0xf
v_fmac_f32_dpp v9, v21, v53 row_newbcast:6 row_mask:0xf bank_mask:0xf
s_nop 0
v_fmac_f32_dpp v8, v21, v54 row_newbcast:7 row_mask:0xf bank_mask:0xf
v_fmac_f32_dpp v9, v21, v55 row_newbcast:7 row_mask:0xf bank_mask:0xf
v_rcp_f32 v24, v23
s_nop 0
v_fma_f32 v25, -v23, v24, 1.0
v_fma_f32 v24, v25, v24, v24
v_mul_f32 v8, v8, v24
v_mul_f32 v9, v9, v24
v_cvt_pk_bf16_f32 v8, v8, v9
v_lshlrev_b32 v25, 2, v32
ds_write_b32 v25, v8 offset:7168
s_lshl_b32 s16, s79, 9
s_add_u32 s16, s16, 1572864
v_and_b32 v20, 31, v32
v_lshlrev_b32 v20, 11, v20
v_lshrrev_b32 v27, 5, v32
v_lshlrev_b32 v23, 3, v27
v_add_u32 v20, v20, v23
s_lshl_b32 s17, s36, 7
s_add_u32 s17, s17, s34
s_lshl_b32 s17, s17, 9
s_lshl_b32 s77, s37, 4
s_add_u32 s17, s17, s77
s_add_u32 s17, s17, 1572864
s_waitcnt lgkmcnt(0)
s_barrier
s_barrier
ds_read_b64 v[40:41], v26 offset:7424
ds_read_b64 v[42:43], v26 offset:7936
ds_read_b64 v[44:45], v26 offset:8448
ds_read_b64 v[46:47], v26 offset:8960
s_waitcnt lgkmcnt(0)
v_add_f32 v40, v40, v42
v_add_f32 v41, v41, v43
v_add_f32 v44, v44, v46
v_add_f32 v45, v45, v47
v_add_f32 v40, v40, v44
v_add_f32 v41, v41, v45
v_min_u32 v40, -2, v40
v_min_u32 v41, -2, v41
buffer_store_dwordx2 v[40:41], v26, s[48:51], s16 offen sc1
L_poll2:
buffer_load_dwordx2 v[42:43], v20, s[48:51], s17 offen sc1
s_waitcnt vmcnt(0)
v_max_u32 v22, v42, v43
v_cmp_eq_u32 vcc, -1, v22
s_cmp_lg_u64 vcc, 0
s_cbranch_scc0 L_got2
s_sub_u32 s85, s85, 1
s_cmp_gt_i32 s85, 0
s_cbranch_scc1 L_poll2
L_got2:
v_add_f32_dpp v42, v42, v42 quad_perm:[1,0,3,2] row_mask:0xf bank_mask:0xf
v_add_f32_dpp v43, v43, v43 quad_perm:[1,0,3,2] row_mask:0xf bank_mask:0xf
s_nop 0
v_add_f32_dpp v42, v42, v42 quad_perm:[2,3,0,1] row_mask:0xf bank_mask:0xf
v_add_f32_dpp v43, v43, v43 quad_perm:[2,3,0,1] row_mask:0xf bank_mask:0xf
s_nop 0
v_add_f32_dpp v42, v42, v42 row_ror:4 row_mask:0xf bank_mask:0xf
v_add_f32_dpp v43, v43, v43 row_ror:4 row_mask:0xf bank_mask:0xf
s_nop 0
v_add_f32_dpp v42, v42, v42 row_ror:8 row_mask:0xf bank_mask:0xf
v_add_f32_dpp v43, v43, v43 row_ror:8 row_mask:0xf bank_mask:0xf
v_mov_b32 v24, v42
s_nop 1
v_permlane16_swap_b32 v42, v24
v_add_f32 v42, v42, v24
v_mov_b32 v24, v43
s_nop 1
v_permlane16_swap_b32 v43, v24
v_add_f32 v43, v43, v24
v_cvt_pk_bf16_f32 v42, v42, v43
s_lshl_b32 s3, s36, 9
s_lshl_b32 s77, s34, 7
s_add_u32 s3, s3, s77
s_lshl_b32 s77, s37, 2
s_add_u32 s3, s3, s77
s_lshl_b32 s3, s3, 1
v_lshlrev_b32 v23, 2, v27
v_and_b32 v24, 31, v32
v_cmp_eq_u32 vcc, 0, v24
s_and_saveexec_b64 s[14:15], vcc
buffer_store_dword v42, v23, s[68:71], s3 offen
s_mov_b64 exec, s[14:15]
L_end:
s_endpgm
.section .rodata,"a"
.p2align 6
.amdhsa_kernel concat_heads__mha_block_cached__mha_block_cached__decode_kernel
  .amdhsa_next_free_vgpr 248
  .amdhsa_next_free_sgpr 102
  .amdhsa_accum_offset 248
  .amdhsa_group_segment_fixed_size 0
  .amdhsa_kernarg_size 104
  .amdhsa_user_sgpr_count 2
  .amdhsa_user_sgpr_kernarg_segment_ptr 1
  .amdhsa_system_sgpr_workgroup_id_x 1
.end_amdhsa_kernel
```
